```python
import torch

def _softmax(x, axis=-1):
    return torch.softmax(x, dim=axis)
def _gelu(x):
    return torch.nn.functional.gelu(x, approximate="tanh")
def _silu(x):
    return torch.nn.functional.silu(x)
def _sigmoid(x):
    return torch.sigmoid(x)
def _layernorm(x, axis=-1, eps=1e-5):
    m = x.mean(dim=axis, keepdim=True)
    v = x.var(dim=axis, keepdim=True, unbiased=False)
    return (x - m) / torch.sqrt(v + eps)
def _scatter_add(tgt, idx, src, axis=0):
    return tgt.clone().index_add_(axis, idx, src)
def _segment_sum(src, seg, n):
    out = torch.zeros((n,) + src.shape[1:], dtype=src.dtype)
    return out.index_add_(0, seg, src)
def _pad(x, pw):
    flat = tuple(v for pair in reversed(pw) for v in pair)
    return torch.nn.functional.pad(x, flat)

kernel_name = 'gated_mix__spectral_gfnet__dense_activation_gelu__prompt'

def setup_inputs():

    _w = (lambda a: (lambda t: t.to(torch.bfloat16) if t.is_floating_point() else t)(torch.as_tensor(a)))
    def _A_setup():
        B, S, D = 1, 2048, 512
        Df = D // 2 + 1
        return {
            "x": _w((lambda *s: torch.randn(*s, dtype=torch.bfloat16) * 0.05)(B, S, D)),
            "w_r": _w((lambda *s: torch.randn(*s, dtype=torch.bfloat16) * 1.6)(S, Df) * 0.02),
            "w_i": _w((lambda *s: torch.randn(*s, dtype=torch.bfloat16) * 1.6)(S, Df) * 0.02),
        }
    _A_in = _A_setup()

    def _B_setup():
        B, S, D, F = 1, 2048, 512, 1376
        return {
            "x": _w((lambda *s: torch.randn(*s, dtype=torch.bfloat16) * 0.05)(B, S, D)),
            "w1": _w((lambda *s: torch.randn(*s, dtype=torch.bfloat16) * 3.2)(D, F) * (D ** -0.5)),
            "b1": _w((lambda *s: torch.randn(*s, dtype=torch.bfloat16) * 3.2)(F) * 0.01),
            "w2": _w((lambda *s: torch.randn(*s, dtype=torch.bfloat16) * 0.05)(F, D) * (F ** -0.5)),
            "b2": _w((lambda *s: torch.randn(*s, dtype=torch.bfloat16) * 0.1)(D) * 0.01),
        }
    _B_in = _B_setup()

    return {
        "A_x": _A_in["x"],
        "A_w_r": _A_in["w_r"],
        "A_w_i": _A_in["w_i"],
        "B_x": _B_in["x"],
        "B_w1": _B_in["w1"],
        "B_b1": _B_in["b1"],
        "B_w2": _B_in["w2"],
        "B_b2": _B_in["b2"],
        "gate_w": _w((lambda *s: torch.randn(*s, dtype=torch.bfloat16) * 0.05)(512) * 16.0),
    }

def reference(A_x, A_w_r, A_w_i, B_x, B_w1, B_b1, B_w2, B_b2, gate_w):
    def _A_ref(x, w_r, w_i):
        B, S, D = x.shape
        X = (lambda x, axes=(-2,-1): torch.fft.rfft2(x.float(), dim=axes))(x, axes=(-2, -1))
        W = w_r + 1j * w_i
        X = X * W
        y = (lambda x, s, axes=(-2,-1): torch.fft.irfft2(x, s=s, dim=axes).to(torch.bfloat16))(X, (S, D), axes=(-2, -1))
        return y

    def _B_ref(x, w1, b1, w2, b2):
        h = torch.einsum("bsd,df->bsf", x, w1) + b1
        h = _gelu(h)
        return torch.einsum("bsf,fd->bsd", h, w2) + b2

    x = A_x
    g = _sigmoid((x * gate_w).sum(-1, keepdims=True))
    a = _A_ref(x, A_w_r, A_w_i)
    b = _B_ref(x, B_w1, B_b1, B_w2, B_b2)
    return g * a + (1 - g) * b
```

```asm
; @launch grid=(256,1,1) block=(512,1,1) lds=163840
.amdgcn_target "amdgcn-amd-amdhsa--gfx950"
.text
.globl gated_mix__spectral_gfnet__dense_activation_gelu__prompt_kernel
.p2align 8
.type gated_mix__spectral_gfnet__dense_activation_gelu__prompt_kernel,@function
gated_mix__spectral_gfnet__dense_activation_gelu__prompt_kernel:
    s_cmp_ge_u32 s2, 256
    s_cbranch_scc1 L_end
    s_getpc_b64 s[52:53]
L_pc:
    v_lshlrev_b32 v1, 7, v0
    s_and_b32 s53, s53, 0xffff
    s_mov_b32 s54, L_end-L_pc
    s_mov_b32 s55, 0x20000
    buffer_load_dword v249, v1, s[52:55], 0 offen
    v_lshrrev_b32 v1, 6, v0
    s_nop 0
    v_readfirstlane_b32 s29, v1
    v_and_b32 v0, 63, v0
    s_nop 2
    s_and_b32 s3, s29, 3
    s_cmp_ge_u32 s29, 4
    s_cbranch_scc1 L_B
    s_load_dwordx2 s[4:5], s[0:1], 0
    s_load_dwordx2 s[12:13], s[0:1], 88
    s_load_dwordx2 s[16:17], s[0:1], 64
    s_load_dwordx2 s[8:9], s[0:1], 16
    s_load_dwordx2 s[44:45], s[0:1], 8
    s_load_dwordx2 s[48:49], s[0:1], 72
    s_load_dwordx2 s[56:57], s[0:1], 80
    s_load_dwordx2 s[36:37], s[0:1], 32
    s_load_dwordx2 s[40:41], s[0:1], 48
    s_and_b32 s30, s2, 7
    s_lshr_b32 s31, s2, 3
    s_lshr_b32 s96, s30, 1
    s_lshl_b32 s96, s96, 3
    s_and_b32 s97, s31, 7
    s_add_u32 s96, s96, s97
    s_and_b32 s97, s30, 1
    s_lshl_b32 s97, s97, 2
    s_lshr_b32 s31, s31, 3
    s_add_u32 s97, s97, s31
    v_lshrrev_b32 v1, 4, v0
    v_and_b32 v2, 15, v0
    v_lshrrev_b32 v3, 3, v0
    v_lshrrev_b32 v4, 4, v0
    v_xor_b32 v4, v4, v0
    v_and_b32 v4, 7, v4
    v_lshlrev_b32 v4, 4, v4
    v_mul_u32_u24 v3, 32768, v3
    v_add_u32 v224, v3, v4
    v_xor_b32 v225, 64, v224
    s_mul_i32 s33, s3, 524288
    s_lshl_b32 s30, s96, 10
    s_add_u32 s33, s33, s30
    s_lshl_b32 s34, s3, 11
    s_and_b32 s20, s2, 7
    s_lshl_b32 s20, s20, 2
    s_lshr_b32 s30, s2, 3
    s_lshr_b32 s21, s30, 2
    s_and_b32 s30, s30, 3
    s_add_u32 s20, s20, s30
    v_mov_b32 v252, 162816
    v_mov_b32 v253, 1
    s_mov_b32 s60, 100000
    s_cmp_lg_u32 s3, 0
    s_cbranch_scc1 Z_1001
    v_lshlrev_b32 v3, 2, v0
    v_add_u32 v3, 162816, v3
    v_mov_b32 v4, 0
    ds_write_b32 v3, v4
    s_waitcnt lgkmcnt(0)
    s_nop 2
Z_1001:
    s_waitcnt lgkmcnt(0)
    s_and_b32 s5, s5, 0xffff
    s_mov_b32 s6, 2097152
    s_mov_b32 s7, 0x20000
    s_lshl_b32 s30, s97, 7
    s_add_u32 s30, s30, s33
    s_add_u32 m0, s34, 0
    s_nop 0
    buffer_load_dwordx4 v224, s[4:7], s30 offen lds
    s_add_u32 s30, s30, 262144
    s_add_u32 m0, s34, 1024
    s_nop 0
    buffer_load_dwordx4 v225, s[4:7], s30 offen lds
    s_and_b32 s9, s9, 0xffff
    s_mov_b32 s10, 1052672
    s_mov_b32 s11, 0x20000
    s_and_b32 s17, s17, 0xffff
    s_mov_b32 s18, 1024
    s_mov_b32 s19, 0x20000
    s_and_b32 s45, s45, 0xffff
    s_mov_b32 s46, 1052672
    s_mov_b32 s47, 0x20000
    s_and_b32 s49, s49, 0xffff
    s_mov_b32 s50, 2097152
    s_mov_b32 s51, 0x20000
    s_and_b32 s57, s57, 0xffff
    s_mov_b32 s58, 256
    s_mov_b32 s59, 0x20000
    s_and_b32 s37, s37, 0xffff
    s_mov_b32 s38, 1409024
    s_mov_b32 s39, 0x20000
    s_and_b32 s41, s41, 0xffff
    s_mov_b32 s42, 1409024
    s_mov_b32 s43, 0x20000
    s_and_b32 s13, s13, 0xffff
    s_mov_b32 s14, 16777216
    s_mov_b32 s15, 0x20000
    s_barrier
    v_lshlrev_b32 v3, 4, v1
    s_lshl_b32 s31, s97, 7
    buffer_load_dwordx4 v[16:19], v3, s[16:19], s31 offen offset:0
    buffer_load_dwordx4 v[20:23], v3, s[16:19], s31 offen offset:64
    s_mov_b32 s63, 15777792
    v_mov_b32 v254, 0
    buffer_load_dword v251, v254, s[12:15], s63 offen sc1
    s_cmp_ge_u32 s3, 1
    s_cbranch_scc1 PF_1002
    s_mul_i32 s62, s2, 43*128
    v_lshlrev_b32 v248, 7, v0
    s_mov_b32 exec_hi, 0x7ff
    buffer_load_dword v249, v248, s[36:39], s62 offen
    s_mov_b64 exec, -1
    s_nop 1
PF_1002:
    s_lshl_b32 s31, s3, 4
    v_add_u32 v3, s31, v2
    v_subrev_u32 v4, 32, v3
    v_cmp_lt_u32 vcc, 32, v3
    s_nop 1
    v_cndmask_b32 v3, v3, v4, vcc
    v_cvt_f32_u32 v3, v3
    v_mul_f32 v3, 0x3c800000, v3
    v_mov_b32 v4, 0
    v_mov_b32 v5, 0xbe800000
    v_cndmask_b32 v4, v4, v5, vcc
    v_lshlrev_b32 v5, 3, v1
    v_cvt_f32_u32 v5, v5
    v_fma_f32 v4, v5, v3, v4
    v_cos_f32 v128, v4
    v_fmamk_f32 v129, v3, 0x3f800000, v4
    v_cos_f32 v129, v129
    v_fmamk_f32 v130, v3, 0x40000000, v4
    v_cos_f32 v130, v130
    v_fmamk_f32 v131, v3, 0x40400000, v4
    v_cos_f32 v131, v131
    v_fmamk_f32 v132, v3, 0x40800000, v4
    v_cos_f32 v132, v132
    v_fmamk_f32 v133, v3, 0x40a00000, v4
    v_cos_f32 v133, v133
    v_fmamk_f32 v134, v3, 0x40c00000, v4
    v_cos_f32 v134, v134
    v_fmamk_f32 v135, v3, 0x40e00000, v4
    v_cos_f32 v135, v135
    v_fmamk_f32 v136, v3, 0x42000000, v4
    v_cos_f32 v136, v136
    v_fmamk_f32 v137, v3, 0x42040000, v4
    v_cos_f32 v137, v137
    v_fmamk_f32 v138, v3, 0x42080000, v4
    v_cos_f32 v138, v138
    v_fmamk_f32 v139, v3, 0x420c0000, v4
    v_cos_f32 v139, v139
    v_fmamk_f32 v140, v3, 0x42100000, v4
    v_cos_f32 v140, v140
    v_fmamk_f32 v141, v3, 0x42140000, v4
    v_cos_f32 v141, v141
    v_fmamk_f32 v142, v3, 0x42180000, v4
    v_cos_f32 v142, v142
    v_fmamk_f32 v143, v3, 0x421c0000, v4
    v_cos_f32 v143, v143
    v_cvt_pk_bf16_f32 v240, v128, v129
    v_cvt_pk_bf16_f32 v241, v130, v131
    v_cvt_pk_bf16_f32 v242, v132, v133
    v_cvt_pk_bf16_f32 v243, v134, v135
    v_cvt_pk_bf16_f32 v244, v136, v137
    v_cvt_pk_bf16_f32 v245, v138, v139
    v_cvt_pk_bf16_f32 v246, v140, v141
    v_cvt_pk_bf16_f32 v247, v142, v143
    v_lshrrev_b32 v3, 2, v2
    v_lshl_add_u32 v4, v1, 3, v3
    v_lshlrev_b32 v4, 7, v4
    v_lshrrev_b32 v3, 1, v3
    v_and_b32 v5, 1, v1
    v_lshl_add_u32 v3, v5, 2, v3
    v_bfe_u32 v5, v2, 1, 1
    v_xor_b32 v3, v3, v5
    v_lshl_add_u32 v4, v3, 4, v4
    v_and_b32 v3, 1, v2
    v_lshl_add_u32 v6, v3, 3, v4
    v_xor_b32 v226, 0, v6
    v_xor_b32 v227, 32, v6
    v_xor_b32 v228, 32, v6
    v_xor_b32 v229, 0, v6
    v_xor_b32 v230, 64, v6
    v_xor_b32 v231, 96, v6
    v_xor_b32 v232, 96, v6
    v_xor_b32 v233, 64, v6
    v_lshrrev_b32 v3, 1, v2
    v_xor_b32 v3, v3, v1
    v_lshlrev_b32 v3, 4, v3
    v_lshl_add_u32 v238, v2, 7, v3
    v_xor_b32 v239, 64, v238
    v_and_b32 v3, 1, v1
    v_lshlrev_b32 v3, 5, v3
    v_lshrrev_b32 v4, 1, v1
    v_lshl_add_u32 v3, v4, 4, v3
    v_lshl_add_u32 v13, v2, 15, v3
    s_lshl_b32 s30, s97, 7
    s_add_u32 s31, s33, s30
    s_waitcnt vmcnt(3)
    s_mov_b64 exec, 1
    ds_add_u32 v252, v253 offset:64
    s_mov_b64 exec, -1
    s_nop 1
W_1003:
    ds_read_b32 v254, v252 offset:64
    s_waitcnt lgkmcnt(0)
    v_readfirstlane_b32 s61, v254
    s_nop 3
    s_cmp_ge_u32 s61, 4
    s_cbranch_scc1 Wd_1004
    s_sub_u32 s60, s60, 1
    s_cbranch_scc0 W_1003
    s_mov_b32 s60, 0
    v_mov_b32 v254, 271
    v_mov_b32 v255, 0
    buffer_store_dword v254, v255, s[56:59], 0 offen offset:60
    s_nop 3
Wd_1004:
    s_cmp_lg_u32 s3, 1
    s_cbranch_scc1 PF_1005
    s_mul_i32 s62, s2, 43*128
    v_lshlrev_b32 v250, 7, v0
    s_mov_b32 exec_hi, 0x7ff
    buffer_load_dword v249, v250, s[40:43], s62 offen
    s_mov_b64 exec, -1
    s_nop 1
PF_1005:
    ds_read_b64_tr_b16 v[128:129], v226 offset:0
    ds_read_b64_tr_b16 v[130:131], v227 offset:512
    ds_read_b64_tr_b16 v[132:133], v226 offset:4096
    ds_read_b64_tr_b16 v[134:135], v227 offset:4608
    ds_read_b64_tr_b16 v[136:137], v228 offset:0
    ds_read_b64_tr_b16 v[138:139], v229 offset:512
    ds_read_b64_tr_b16 v[140:141], v228 offset:4096
    ds_read_b64_tr_b16 v[142:143], v229 offset:4608
    ds_read_b64_tr_b16 v[144:145], v230 offset:0
    ds_read_b64_tr_b16 v[146:147], v231 offset:512
    ds_read_b64_tr_b16 v[148:149], v230 offset:4096
    ds_read_b64_tr_b16 v[150:151], v231 offset:4608
    ds_read_b64_tr_b16 v[152:153], v232 offset:0
    ds_read_b64_tr_b16 v[154:155], v233 offset:512
    ds_read_b64_tr_b16 v[156:157], v232 offset:4096
    ds_read_b64_tr_b16 v[158:159], v233 offset:4608
    s_waitcnt lgkmcnt(0)
    v_mfma_f32_16x16x32_bf16 v[160:163], v[128:131], v[240:243], 0
    v_mfma_f32_16x16x32_bf16 v[164:167], v[136:139], v[240:243], 0
    v_mfma_f32_16x16x32_bf16 v[168:171], v[144:147], v[240:243], 0
    v_mfma_f32_16x16x32_bf16 v[172:175], v[152:155], v[240:243], 0
    v_mfma_f32_16x16x32_bf16 v[160:163], v[132:135], v[244:247], v[160:163]
    v_mfma_f32_16x16x32_bf16 v[164:167], v[140:143], v[244:247], v[164:167]
    v_mfma_f32_16x16x32_bf16 v[168:171], v[148:151], v[244:247], v[168:171]
    v_mfma_f32_16x16x32_bf16 v[172:175], v[156:159], v[244:247], v[172:175]
    s_nop 4
    v_cvt_pk_bf16_f32 v128, v160, v161
    v_cvt_pk_bf16_f32 v129, v162, v163
    v_cvt_pk_bf16_f32 v130, v164, v165
    v_cvt_pk_bf16_f32 v131, v166, v167
    v_cvt_pk_bf16_f32 v132, v168, v169
    v_cvt_pk_bf16_f32 v133, v170, v171
    v_cvt_pk_bf16_f32 v134, v172, v173
    v_cvt_pk_bf16_f32 v135, v174, v175
    v_permlane16_swap_b32 v128, v130
    v_permlane16_swap_b32 v129, v131
    v_permlane16_swap_b32 v132, v134
    v_permlane16_swap_b32 v133, v135
    buffer_store_dwordx4 v[128:131], v13, s[12:15], s31 offen offset:0 sc1
    buffer_store_dwordx4 v[132:135], v13, s[12:15], s31 offen offset:64 sc1
    s_nop 2
    s_cmp_lg_u32 s3, 0
    s_cbranch_scc1 A1g_1006
    ds_read_b128 v[24:27], v238 offset:0
    ds_read_b128 v[28:31], v239 offset:0
    ds_read_b128 v[32:35], v238 offset:2048
    ds_read_b128 v[36:39], v239 offset:2048
    ds_read_b128 v[40:43], v238 offset:4096
    ds_read_b128 v[44:47], v239 offset:4096
    ds_read_b128 v[48:51], v238 offset:6144
    ds_read_b128 v[52:55], v239 offset:6144
    s_waitcnt vmcnt(3)
    s_waitcnt lgkmcnt(0)
    v_mfma_f32_16x16x32_bf16 v[176:179], v[16:19], v[24:27], 0
    v_mfma_f32_16x16x32_bf16 v[180:183], v[16:19], v[32:35], 0
    v_mfma_f32_16x16x32_bf16 v[184:187], v[16:19], v[40:43], 0
    v_mfma_f32_16x16x32_bf16 v[188:191], v[16:19], v[48:51], 0
    v_mfma_f32_16x16x32_bf16 v[176:179], v[20:23], v[28:31], v[176:179]
    v_mfma_f32_16x16x32_bf16 v[180:183], v[20:23], v[36:39], v[180:183]
    v_mfma_f32_16x16x32_bf16 v[184:187], v[20:23], v[44:47], v[184:187]
    v_mfma_f32_16x16x32_bf16 v[188:191], v[20:23], v[52:55], v[188:191]
    s_nop 7
    v_mov_b32 v177, v180
    v_mov_b32 v178, v184
    v_mov_b32 v179, v188
    s_lshl_b32 s32, s96, 3
    s_add_u32 s32, s32, s97
    s_lshl_b32 s32, s32, 8
    s_add_u32 s32, s32, 10485760
    v_lshlrev_b32 v3, 4, v2
    s_mov_b64 exec, 0xffff
    buffer_store_dwordx4 v[176:179], v3, s[12:15], s32 offen sc1
    s_mov_b64 exec, -1
    s_nop 1
A1g_1006:
    s_waitcnt vmcnt(0)
    v_add_u32 v251, 0x9e3779b9, v251
    s_waitcnt vmcnt(0)
    s_mov_b64 exec, 1
    ds_add_rtn_u32 v254, v252, v253 offset:8
    s_waitcnt lgkmcnt(0)
    v_readfirstlane_b32 s61, v254
    s_nop 3
    s_cmp_lg_u32 s61, 3
    s_cbranch_scc1 P_1007
    s_lshr_b32 s63, s2, 2
    s_mul_i32 s63, s63, 32
    s_and_b32 s61, s2, 3
    s_lshl_b32 s61, s61, 2
    s_add_u32 s63, s63, s61
    s_add_u32 s63, s63, 15728640
    s_mov_b64 exec, 255
    v_mul_u32_u24 v254, 2048, v0
    buffer_store_dword v251, v254, s[12:15], s63 offen sc1
    s_nop 3
P_1007:
    s_mov_b64 exec, -1
    s_lshl_b32 s22, s21, 5
    s_lshl_b32 s23, s3, 3
    s_add_u32 s22, s22, s23
    v_lshrrev_b32 v3, 1, v2
    v_add_u32 v3, s22, v3
    v_cmp_eq_u32 vcc, 0, v3
    v_mov_b32 v4, 1.0
    s_nop 0
    v_cndmask_b32_e64 v7, 1.0, 0, vcc
    v_cndmask_b32_e64 v8, -1.0, 0, vcc
    v_cvt_f32_u32 v3, v3
    v_mul_f32 v3, 0x3b000000, v3
    v_and_b32 v4, 1, v2
    v_cvt_f32_u32 v5, v4
    v_mul_f32 v5, 0xbe800000, v5
    v_cvt_f32_u32 v4, v4
    v_cndmask_b32_e64 v4, 0, v4, vcc
    v_fma_f32 v3, v4, 0.5, v3
    v_mul_f32 v6, 0x3e800000, v4
    v_add_f32 v5, v5, v6
    v_lshlrev_b32 v4, 3, v1
    v_cvt_f32_u32 v4, v4
    v_fma_f32 v5, v4, v3, v5
    v_mul_f32 v144, 0x42000000, v3
    v_cos_f32 v144, v144
    v_cos_f32 v128, v5
    v_fmamk_f32 v136, v3, 0x42000000, v5
    v_cos_f32 v136, v136
    v_fmamk_f32 v129, v3, 0x3f800000, v5
    v_cos_f32 v129, v129
    v_fmamk_f32 v137, v3, 0x42040000, v5
    v_cos_f32 v137, v137
    v_fmamk_f32 v130, v3, 0x40000000, v5
    v_cos_f32 v130, v130
    v_fmamk_f32 v138, v3, 0x42080000, v5
    v_cos_f32 v138, v138
    v_fmamk_f32 v131, v3, 0x40400000, v5
    v_cos_f32 v131, v131
    v_fmamk_f32 v139, v3, 0x420c0000, v5
    v_cos_f32 v139, v139
    v_fmamk_f32 v132, v3, 0x40800000, v5
    v_cos_f32 v132, v132
    v_fmamk_f32 v140, v3, 0x42100000, v5
    v_cos_f32 v140, v140
    v_fmamk_f32 v133, v3, 0x40a00000, v5
    v_cos_f32 v133, v133
    v_fmamk_f32 v141, v3, 0x42140000, v5
    v_cos_f32 v141, v141
    v_fmamk_f32 v134, v3, 0x40c00000, v5
    v_cos_f32 v134, v134
    v_fmamk_f32 v142, v3, 0x42180000, v5
    v_cos_f32 v142, v142
    v_fmamk_f32 v135, v3, 0x40e00000, v5
    v_cos_f32 v135, v135
    v_fmamk_f32 v143, v3, 0x421c0000, v5
    v_cos_f32 v143, v143
    v_add_f32 v144, v144, v144
    v_cvt_pk_bf16_f32 v64, v128, v129
    v_cvt_pk_bf16_f32 v65, v130, v131
    v_cvt_pk_bf16_f32 v66, v132, v133
    v_cvt_pk_bf16_f32 v67, v134, v135
    v_cvt_pk_bf16_f32 v68, v136, v137
    v_cvt_pk_bf16_f32 v69, v138, v139
    v_cvt_pk_bf16_f32 v70, v140, v141
    v_cvt_pk_bf16_f32 v71, v142, v143
    v_fma_f32 v128, v144, v136, -v128
    v_fma_f32 v129, v144, v137, -v129
    v_fma_f32 v130, v144, v138, -v130
    v_fma_f32 v131, v144, v139, -v131
    v_fma_f32 v132, v144, v140, -v132
    v_fma_f32 v133, v144, v141, -v133
    v_fma_f32 v134, v144, v142, -v134
    v_fma_f32 v135, v144, v143, -v135
    v_cvt_pk_bf16_f32 v72, v128, v129
    v_cvt_pk_bf16_f32 v73, v130, v131
    v_cvt_pk_bf16_f32 v74, v132, v133
    v_cvt_pk_bf16_f32 v75, v134, v135
    v_fma_f32 v136, v144, v128, -v136
    v_fma_f32 v137, v144, v129, -v137
    v_fma_f32 v138, v144, v130, -v138
    v_fma_f32 v139, v144, v131, -v139
    v_fma_f32 v140, v144, v132, -v140
    v_fma_f32 v141, v144, v133, -v141
    v_fma_f32 v142, v144, v134, -v142
    v_fma_f32 v143, v144, v135, -v143
    v_cvt_pk_bf16_f32 v76, v136, v137
    v_cvt_pk_bf16_f32 v77, v138, v139
    v_cvt_pk_bf16_f32 v78, v140, v141
    v_cvt_pk_bf16_f32 v79, v142, v143
    v_fma_f32 v128, v144, v136, -v128
    v_fma_f32 v129, v144, v137, -v129
    v_fma_f32 v130, v144, v138, -v130
    v_fma_f32 v131, v144, v139, -v131
    v_fma_f32 v132, v144, v140, -v132
    v_fma_f32 v133, v144, v141, -v133
    v_fma_f32 v134, v144, v142, -v134
    v_fma_f32 v135, v144, v143, -v135
    v_cvt_pk_bf16_f32 v80, v128, v129
    v_cvt_pk_bf16_f32 v81, v130, v131
    v_cvt_pk_bf16_f32 v82, v132, v133
    v_cvt_pk_bf16_f32 v83, v134, v135
    v_fma_f32 v136, v144, v128, -v136
    v_fma_f32 v137, v144, v129, -v137
    v_fma_f32 v138, v144, v130, -v138
    v_fma_f32 v139, v144, v131, -v139
    v_fma_f32 v140, v144, v132, -v140
    v_fma_f32 v141, v144, v133, -v141
    v_fma_f32 v142, v144, v134, -v142
    v_fma_f32 v143, v144, v135, -v143
    v_cvt_pk_bf16_f32 v84, v136, v137
    v_cvt_pk_bf16_f32 v85, v138, v139
    v_cvt_pk_bf16_f32 v86, v140, v141
    v_cvt_pk_bf16_f32 v87, v142, v143
    v_fma_f32 v128, v144, v136, -v128
    v_fma_f32 v129, v144, v137, -v129
    v_fma_f32 v130, v144, v138, -v130
    v_fma_f32 v131, v144, v139, -v131
    v_fma_f32 v132, v144, v140, -v132
    v_fma_f32 v133, v144, v141, -v133
    v_fma_f32 v134, v144, v142, -v134
    v_fma_f32 v135, v144, v143, -v135
    v_cvt_pk_bf16_f32 v88, v128, v129
    v_cvt_pk_bf16_f32 v89, v130, v131
    v_cvt_pk_bf16_f32 v90, v132, v133
    v_cvt_pk_bf16_f32 v91, v134, v135
    v_fma_f32 v136, v144, v128, -v136
    v_fma_f32 v137, v144, v129, -v137
    v_fma_f32 v138, v144, v130, -v138
    v_fma_f32 v139, v144, v131, -v139
    v_fma_f32 v140, v144, v132, -v140
    v_fma_f32 v141, v144, v133, -v141
    v_fma_f32 v142, v144, v134, -v142
    v_fma_f32 v143, v144, v135, -v143
    v_cvt_pk_bf16_f32 v92, v136, v137
    v_cvt_pk_bf16_f32 v93, v138, v139
    v_cvt_pk_bf16_f32 v94, v140, v141
    v_cvt_pk_bf16_f32 v95, v142, v143
    v_fma_f32 v128, v144, v136, -v128
    v_fma_f32 v129, v144, v137, -v129
    v_fma_f32 v130, v144, v138, -v130
    v_fma_f32 v131, v144, v139, -v131
    v_fma_f32 v132, v144, v140, -v132
    v_fma_f32 v133, v144, v141, -v133
    v_fma_f32 v134, v144, v142, -v134
    v_fma_f32 v135, v144, v143, -v135
    v_cvt_pk_bf16_f32 v96, v128, v129
    v_cvt_pk_bf16_f32 v97, v130, v131
    v_cvt_pk_bf16_f32 v98, v132, v133
    v_cvt_pk_bf16_f32 v99, v134, v135
    v_fma_f32 v136, v144, v128, -v136
    v_fma_f32 v137, v144, v129, -v137
    v_fma_f32 v138, v144, v130, -v138
    v_fma_f32 v139, v144, v131, -v139
    v_fma_f32 v140, v144, v132, -v140
    v_fma_f32 v141, v144, v133, -v141
    v_fma_f32 v142, v144, v134, -v142
    v_fma_f32 v143, v144, v135, -v143
    v_cvt_pk_bf16_f32 v100, v136, v137
    v_cvt_pk_bf16_f32 v101, v138, v139
    v_cvt_pk_bf16_f32 v102, v140, v141
    v_cvt_pk_bf16_f32 v103, v142, v143
    v_fma_f32 v128, v144, v136, -v128
    v_fma_f32 v129, v144, v137, -v129
    v_fma_f32 v130, v144, v138, -v130
    v_fma_f32 v131, v144, v139, -v131
    v_fma_f32 v132, v144, v140, -v132
    v_fma_f32 v133, v144, v141, -v133
    v_fma_f32 v134, v144, v142, -v134
    v_fma_f32 v135, v144, v143, -v135
    v_cvt_pk_bf16_f32 v104, v128, v129
    v_cvt_pk_bf16_f32 v105, v130, v131
    v_cvt_pk_bf16_f32 v106, v132, v133
    v_cvt_pk_bf16_f32 v107, v134, v135
    v_fma_f32 v136, v144, v128, -v136
    v_fma_f32 v137, v144, v129, -v137
    v_fma_f32 v138, v144, v130, -v138
    v_fma_f32 v139, v144, v131, -v139
    v_fma_f32 v140, v144, v132, -v140
    v_fma_f32 v141, v144, v133, -v141
    v_fma_f32 v142, v144, v134, -v142
    v_fma_f32 v143, v144, v135, -v143
    v_cvt_pk_bf16_f32 v108, v136, v137
    v_cvt_pk_bf16_f32 v109, v138, v139
    v_cvt_pk_bf16_f32 v110, v140, v141
    v_cvt_pk_bf16_f32 v111, v142, v143
    v_fma_f32 v128, v144, v136, -v128
    v_fma_f32 v129, v144, v137, -v129
    v_fma_f32 v130, v144, v138, -v130
    v_fma_f32 v131, v144, v139, -v131
    v_fma_f32 v132, v144, v140, -v132
    v_fma_f32 v133, v144, v141, -v133
    v_fma_f32 v134, v144, v142, -v134
    v_fma_f32 v135, v144, v143, -v135
    v_cvt_pk_bf16_f32 v112, v128, v129
    v_cvt_pk_bf16_f32 v113, v130, v131
    v_cvt_pk_bf16_f32 v114, v132, v133
    v_cvt_pk_bf16_f32 v115, v134, v135
    v_fma_f32 v136, v144, v128, -v136
    v_fma_f32 v137, v144, v129, -v137
    v_fma_f32 v138, v144, v130, -v138
    v_fma_f32 v139, v144, v131, -v139
    v_fma_f32 v140, v144, v132, -v140
    v_fma_f32 v141, v144, v133, -v141
    v_fma_f32 v142, v144, v134, -v142
    v_fma_f32 v143, v144, v135, -v143
    v_cvt_pk_bf16_f32 v116, v136, v137
    v_cvt_pk_bf16_f32 v117, v138, v139
    v_cvt_pk_bf16_f32 v118, v140, v141
    v_cvt_pk_bf16_f32 v119, v142, v143
    v_fma_f32 v128, v144, v136, -v128
    v_fma_f32 v129, v144, v137, -v129
    v_fma_f32 v130, v144, v138, -v130
    v_fma_f32 v131, v144, v139, -v131
    v_fma_f32 v132, v144, v140, -v132
    v_fma_f32 v133, v144, v141, -v133
    v_fma_f32 v134, v144, v142, -v134
    v_fma_f32 v135, v144, v143, -v135
    v_cvt_pk_bf16_f32 v120, v128, v129
    v_cvt_pk_bf16_f32 v121, v130, v131
    v_cvt_pk_bf16_f32 v122, v132, v133
    v_cvt_pk_bf16_f32 v123, v134, v135
    v_fma_f32 v136, v144, v128, -v136
    v_fma_f32 v137, v144, v129, -v137
    v_fma_f32 v138, v144, v130, -v138
    v_fma_f32 v139, v144, v131, -v139
    v_fma_f32 v140, v144, v132, -v140
    v_fma_f32 v141, v144, v133, -v141
    v_fma_f32 v142, v144, v134, -v142
    v_fma_f32 v143, v144, v135, -v143
    v_cvt_pk_bf16_f32 v124, v136, v137
    v_cvt_pk_bf16_f32 v125, v138, v139
    v_cvt_pk_bf16_f32 v126, v140, v141
    v_cvt_pk_bf16_f32 v127, v142, v143
    v_lshlrev_b32 v6, 2, v1
    v_cvt_f32_u32 v6, v6
    v_lshlrev_b32 v3, 6, v2
    v_add_u32 v3, s20, v3
    v_cvt_f32_u32 v3, v3
    v_mul_f32 v3, 0x3a000000, v3
    v_mul_f32 v4, v3, v6
    v_cos_f32 v128, v4
    v_sin_f32 v136, v4
    v_fmamk_f32 v145, v3, 0x3f800000, v4
    v_cos_f32 v129, v145
    v_sin_f32 v137, v145
    v_fmamk_f32 v146, v3, 0x40000000, v4
    v_cos_f32 v130, v146
    v_sin_f32 v138, v146
    v_fmamk_f32 v147, v3, 0x40400000, v4
    v_cos_f32 v131, v147
    v_sin_f32 v139, v147
    v_fmamk_f32 v148, v3, 0x41800000, v4
    v_cos_f32 v132, v148
    v_sin_f32 v140, v148
    v_fmamk_f32 v149, v3, 0x41880000, v4
    v_cos_f32 v133, v149
    v_sin_f32 v141, v149
    v_fmamk_f32 v150, v3, 0x41900000, v4
    v_cos_f32 v134, v150
    v_sin_f32 v142, v150
    v_fmamk_f32 v151, v3, 0x41980000, v4
    v_cos_f32 v135, v151
    v_sin_f32 v143, v151
    v_cvt_pk_bf16_f32 v176, v128, v129
    v_cvt_pk_bf16_f32 v184, v136, v137
    v_cvt_pk_bf16_f32 v177, v130, v131
    v_cvt_pk_bf16_f32 v185, v138, v139
    v_cvt_pk_bf16_f32 v178, v132, v133
    v_cvt_pk_bf16_f32 v186, v140, v141
    v_cvt_pk_bf16_f32 v179, v134, v135
    v_cvt_pk_bf16_f32 v187, v142, v143
    v_lshlrev_b32 v3, 6, v2
    v_add_u32 v3, s20, v3
    v_add_u32 v3, 1024, v3
    v_cvt_f32_u32 v3, v3
    v_mul_f32 v3, 0x3a000000, v3
    v_mul_f32 v4, v3, v6
    v_cos_f32 v128, v4
    v_sin_f32 v136, v4
    v_fmamk_f32 v145, v3, 0x3f800000, v4
    v_cos_f32 v129, v145
    v_sin_f32 v137, v145
    v_fmamk_f32 v146, v3, 0x40000000, v4
    v_cos_f32 v130, v146
    v_sin_f32 v138, v146
    v_fmamk_f32 v147, v3, 0x40400000, v4
    v_cos_f32 v131, v147
    v_sin_f32 v139, v147
    v_fmamk_f32 v148, v3, 0x41800000, v4
    v_cos_f32 v132, v148
    v_sin_f32 v140, v148
    v_fmamk_f32 v149, v3, 0x41880000, v4
    v_cos_f32 v133, v149
    v_sin_f32 v141, v149
    v_fmamk_f32 v150, v3, 0x41900000, v4
    v_cos_f32 v134, v150
    v_sin_f32 v142, v150
    v_fmamk_f32 v151, v3, 0x41980000, v4
    v_cos_f32 v135, v151
    v_sin_f32 v143, v151
    v_cvt_pk_bf16_f32 v180, v128, v129
    v_cvt_pk_bf16_f32 v188, v136, v137
    v_cvt_pk_bf16_f32 v181, v130, v131
    v_cvt_pk_bf16_f32 v189, v138, v139
    v_cvt_pk_bf16_f32 v182, v132, v133
    v_cvt_pk_bf16_f32 v190, v140, v141
    v_cvt_pk_bf16_f32 v183, v134, v135
    v_cvt_pk_bf16_f32 v191, v142, v143
    v_add_u32 v3, 0, v2
    v_mul_u32_u24 v4, s20, v3
    v_cvt_f32_u32 v4, v4
    v_mul_f32 v4, 0x3a000000, v4
    v_cvt_f32_u32 v3, v3
    v_mul_f32 v3, 0x3d000000, v3
    v_fma_f32 v4, v3, v6, v4
    v_cos_f32 v128, v4
    v_sin_f32 v136, v4
    v_fmamk_f32 v145, v3, 0x3f800000, v4
    v_cos_f32 v129, v145
    v_sin_f32 v137, v145
    v_fmamk_f32 v146, v3, 0x40000000, v4
    v_cos_f32 v130, v146
    v_sin_f32 v138, v146
    v_fmamk_f32 v147, v3, 0x40400000, v4
    v_cos_f32 v131, v147
    v_sin_f32 v139, v147
    v_fmamk_f32 v148, v3, 0x41800000, v4
    v_cos_f32 v132, v148
    v_sin_f32 v140, v148
    v_fmamk_f32 v149, v3, 0x41880000, v4
    v_cos_f32 v133, v149
    v_sin_f32 v141, v149
    v_fmamk_f32 v150, v3, 0x41900000, v4
    v_cos_f32 v134, v150
    v_sin_f32 v142, v150
    v_fmamk_f32 v151, v3, 0x41980000, v4
    v_cos_f32 v135, v151
    v_sin_f32 v143, v151
    v_cvt_pk_bf16_f32 v192, v128, v129
    v_cvt_pk_bf16_f32 v200, v136, v137
    v_cvt_pk_bf16_f32 v193, v130, v131
    v_cvt_pk_bf16_f32 v201, v138, v139
    v_cvt_pk_bf16_f32 v194, v132, v133
    v_cvt_pk_bf16_f32 v202, v140, v141
    v_cvt_pk_bf16_f32 v195, v134, v135
    v_cvt_pk_bf16_f32 v203, v142, v143
    v_add_u32 v3, 16, v2
    v_mul_u32_u24 v4, s20, v3
    v_cvt_f32_u32 v4, v4
    v_mul_f32 v4, 0x3a000000, v4
    v_cvt_f32_u32 v3, v3
    v_mul_f32 v3, 0x3d000000, v3
    v_fma_f32 v4, v3, v6, v4
    v_cos_f32 v128, v4
    v_sin_f32 v136, v4
    v_fmamk_f32 v145, v3, 0x3f800000, v4
    v_cos_f32 v129, v145
    v_sin_f32 v137, v145
    v_fmamk_f32 v146, v3, 0x40000000, v4
    v_cos_f32 v130, v146
    v_sin_f32 v138, v146
    v_fmamk_f32 v147, v3, 0x40400000, v4
    v_cos_f32 v131, v147
    v_sin_f32 v139, v147
    v_fmamk_f32 v148, v3, 0x41800000, v4
    v_cos_f32 v132, v148
    v_sin_f32 v140, v148
    v_fmamk_f32 v149, v3, 0x41880000, v4
    v_cos_f32 v133, v149
    v_sin_f32 v141, v149
    v_fmamk_f32 v150, v3, 0x41900000, v4
    v_cos_f32 v134, v150
    v_sin_f32 v142, v150
    v_fmamk_f32 v151, v3, 0x41980000, v4
    v_cos_f32 v135, v151
    v_sin_f32 v143, v151
    v_cvt_pk_bf16_f32 v196, v128, v129
    v_cvt_pk_bf16_f32 v204, v136, v137
    v_cvt_pk_bf16_f32 v197, v130, v131
    v_cvt_pk_bf16_f32 v205, v138, v139
    v_cvt_pk_bf16_f32 v198, v132, v133
    v_cvt_pk_bf16_f32 v206, v140, v141
    v_cvt_pk_bf16_f32 v199, v134, v135
    v_cvt_pk_bf16_f32 v207, v142, v143
    s_cmp_lg_u32 s20, 0
    s_cselect_b32 s26, 1.0, 0
    s_cmp_lg_u32 s20, 0
    s_nop 1
    s_cbranch_scc1 A2s3_1008
    s_mov_b32 s25, 32
    v_lshlrev_b32 v6, 2, v1
    v_cvt_f32_u32 v6, v6
    v_lshlrev_b32 v3, 6, v2
    v_add_u32 v3, s25, v3
    v_cvt_f32_u32 v3, v3
    v_mul_f32 v3, 0x3a000000, v3
    v_mul_f32 v4, v3, v6
    v_cos_f32 v128, v4
    v_sin_f32 v136, v4
    v_fmamk_f32 v145, v3, 0x3f800000, v4
    v_cos_f32 v129, v145
    v_sin_f32 v137, v145
    v_fmamk_f32 v146, v3, 0x40000000, v4
    v_cos_f32 v130, v146
    v_sin_f32 v138, v146
    v_fmamk_f32 v147, v3, 0x40400000, v4
    v_cos_f32 v131, v147
    v_sin_f32 v139, v147
    v_fmamk_f32 v148, v3, 0x41800000, v4
    v_cos_f32 v132, v148
    v_sin_f32 v140, v148
    v_fmamk_f32 v149, v3, 0x41880000, v4
    v_cos_f32 v133, v149
    v_sin_f32 v141, v149
    v_fmamk_f32 v150, v3, 0x41900000, v4
    v_cos_f32 v134, v150
    v_sin_f32 v142, v150
    v_fmamk_f32 v151, v3, 0x41980000, v4
    v_cos_f32 v135, v151
    v_sin_f32 v143, v151
    v_cvt_pk_bf16_f32 v16, v128, v129
    v_cvt_pk_bf16_f32 v24, v136, v137
    v_cvt_pk_bf16_f32 v17, v130, v131
    v_cvt_pk_bf16_f32 v25, v138, v139
    v_cvt_pk_bf16_f32 v18, v132, v133
    v_cvt_pk_bf16_f32 v26, v140, v141
    v_cvt_pk_bf16_f32 v19, v134, v135
    v_cvt_pk_bf16_f32 v27, v142, v143
    v_lshlrev_b32 v3, 6, v2
    v_add_u32 v3, s25, v3
    v_add_u32 v3, 1024, v3
    v_cvt_f32_u32 v3, v3
    v_mul_f32 v3, 0x3a000000, v3
    v_mul_f32 v4, v3, v6
    v_cos_f32 v128, v4
    v_sin_f32 v136, v4
    v_fmamk_f32 v145, v3, 0x3f800000, v4
    v_cos_f32 v129, v145
    v_sin_f32 v137, v145
    v_fmamk_f32 v146, v3, 0x40000000, v4
    v_cos_f32 v130, v146
    v_sin_f32 v138, v146
    v_fmamk_f32 v147, v3, 0x40400000, v4
    v_cos_f32 v131, v147
    v_sin_f32 v139, v147
    v_fmamk_f32 v148, v3, 0x41800000, v4
    v_cos_f32 v132, v148
    v_sin_f32 v140, v148
    v_fmamk_f32 v149, v3, 0x41880000, v4
    v_cos_f32 v133, v149
    v_sin_f32 v141, v149
    v_fmamk_f32 v150, v3, 0x41900000, v4
    v_cos_f32 v134, v150
    v_sin_f32 v142, v150
    v_fmamk_f32 v151, v3, 0x41980000, v4
    v_cos_f32 v135, v151
    v_sin_f32 v143, v151
    v_cvt_pk_bf16_f32 v20, v128, v129
    v_cvt_pk_bf16_f32 v28, v136, v137
    v_cvt_pk_bf16_f32 v21, v130, v131
    v_cvt_pk_bf16_f32 v29, v138, v139
    v_cvt_pk_bf16_f32 v22, v132, v133
    v_cvt_pk_bf16_f32 v30, v140, v141
    v_cvt_pk_bf16_f32 v23, v134, v135
    v_cvt_pk_bf16_f32 v31, v142, v143
    v_add_u32 v3, 0, v2
    v_mul_u32_u24 v4, s25, v3
    v_cvt_f32_u32 v4, v4
    v_mul_f32 v4, 0x3a000000, v4
    v_cvt_f32_u32 v3, v3
    v_mul_f32 v3, 0x3d000000, v3
    v_fma_f32 v4, v3, v6, v4
    v_cos_f32 v128, v4
    v_sin_f32 v136, v4
    v_fmamk_f32 v145, v3, 0x3f800000, v4
    v_cos_f32 v129, v145
    v_sin_f32 v137, v145
    v_fmamk_f32 v146, v3, 0x40000000, v4
    v_cos_f32 v130, v146
    v_sin_f32 v138, v146
    v_fmamk_f32 v147, v3, 0x40400000, v4
    v_cos_f32 v131, v147
    v_sin_f32 v139, v147
    v_fmamk_f32 v148, v3, 0x41800000, v4
    v_cos_f32 v132, v148
    v_sin_f32 v140, v148
    v_fmamk_f32 v149, v3, 0x41880000, v4
    v_cos_f32 v133, v149
    v_sin_f32 v141, v149
    v_fmamk_f32 v150, v3, 0x41900000, v4
    v_cos_f32 v134, v150
    v_sin_f32 v142, v150
    v_fmamk_f32 v151, v3, 0x41980000, v4
    v_cos_f32 v135, v151
    v_sin_f32 v143, v151
    v_cvt_pk_bf16_f32 v32, v128, v129
    v_cvt_pk_bf16_f32 v40, v136, v137
    v_cvt_pk_bf16_f32 v33, v130, v131
    v_cvt_pk_bf16_f32 v41, v138, v139
    v_cvt_pk_bf16_f32 v34, v132, v133
    v_cvt_pk_bf16_f32 v42, v140, v141
    v_cvt_pk_bf16_f32 v35, v134, v135
    v_cvt_pk_bf16_f32 v43, v142, v143
    v_add_u32 v3, 16, v2
    v_mul_u32_u24 v4, s25, v3
    v_cvt_f32_u32 v4, v4
    v_mul_f32 v4, 0x3a000000, v4
    v_cvt_f32_u32 v3, v3
    v_mul_f32 v3, 0x3d000000, v3
    v_fma_f32 v4, v3, v6, v4
    v_cos_f32 v128, v4
    v_sin_f32 v136, v4
    v_fmamk_f32 v145, v3, 0x3f800000, v4
    v_cos_f32 v129, v145
    v_sin_f32 v137, v145
    v_fmamk_f32 v146, v3, 0x40000000, v4
    v_cos_f32 v130, v146
    v_sin_f32 v138, v146
    v_fmamk_f32 v147, v3, 0x40400000, v4
    v_cos_f32 v131, v147
    v_sin_f32 v139, v147
    v_fmamk_f32 v148, v3, 0x41800000, v4
    v_cos_f32 v132, v148
    v_sin_f32 v140, v148
    v_fmamk_f32 v149, v3, 0x41880000, v4
    v_cos_f32 v133, v149
    v_sin_f32 v141, v149
    v_fmamk_f32 v150, v3, 0x41900000, v4
    v_cos_f32 v134, v150
    v_sin_f32 v142, v150
    v_fmamk_f32 v151, v3, 0x41980000, v4
    v_cos_f32 v135, v151
    v_sin_f32 v143, v151
    v_cvt_pk_bf16_f32 v36, v128, v129
    v_cvt_pk_bf16_f32 v44, v136, v137
    v_cvt_pk_bf16_f32 v37, v130, v131
    v_cvt_pk_bf16_f32 v45, v138, v139
    v_cvt_pk_bf16_f32 v38, v132, v133
    v_cvt_pk_bf16_f32 v46, v140, v141
    v_cvt_pk_bf16_f32 v39, v134, v135
    v_cvt_pk_bf16_f32 v47, v142, v143
    s_nop 4
A2s3_1008:
    v_add_u32 v3, 0, v1
    v_xor_b32 v3, v3, v2
    v_lshlrev_b32 v3, 4, v3
    v_lshl_add_u32 v9, v2, 10, v3
    v_add_u32 v3, 4, v1
    v_xor_b32 v3, v3, v2
    v_lshlrev_b32 v3, 4, v3
    v_lshl_add_u32 v10, v2, 10, v3
    v_add_u32 v3, 8, v1
    v_xor_b32 v3, v3, v2
    v_lshlrev_b32 v3, 4, v3
    v_lshl_add_u32 v11, v2, 10, v3
    v_add_u32 v3, 12, v1
    v_xor_b32 v3, v3, v2
    v_lshlrev_b32 v3, 4, v3
    v_lshl_add_u32 v12, v2, 10, v3
    v_lshlrev_b32 v3, 4, v1
    v_lshl_add_u32 v13, v2, 16, v3
    v_lshrrev_b32 v3, 3, v0
    v_bfe_u32 v4, v3, 1, 1
    v_bfe_u32 v5, v0, 1, 2
    v_xor_b32 v4, v4, v5
    v_lshlrev_b32 v4, 5, v4
    v_and_b32 v5, 1, v0
    v_lshl_add_u32 v4, v5, 4, v4
    v_lshl_add_u32 v238, v3, 10, v4
    v_lshrrev_b32 v3, 3, v0
    v_bfe_u32 v4, v3, 1, 1
    v_or_b32 v4, 2, v4
    v_bfe_u32 v5, v0, 1, 2
    v_xor_b32 v4, v4, v5
    v_lshlrev_b32 v4, 5, v4
    v_and_b32 v5, 1, v0
    v_lshl_add_u32 v4, v5, 4, v4
    v_lshl_add_u32 v239, v3, 10, v4
    s_mul_i32 s36, s3, 360448
    s_lshl_b32 s38, s21, 7
    s_add_u32 s36, s36, s38
    s_mul_i32 s37, s3, 16384
    s_add_u32 s37, s37, 65536
    s_lshl_b32 s22, s3, 2
    s_add_u32 s22, s22, 0
    v_xor_b32 v14, s22, v0
    v_lshlrev_b32 v14, 4, v14
    s_lshl_b32 s22, s3, 2
    s_add_u32 s22, s22, 1
    v_xor_b32 v15, s22, v0
    v_lshlrev_b32 v15, 4, v15
    s_lshl_b32 s22, s3, 2
    s_add_u32 s22, s22, 2
    v_xor_b32 v224, s22, v0
    v_lshlrev_b32 v224, 4, v224
    s_lshl_b32 s22, s3, 2
    s_add_u32 s22, s22, 3
    v_xor_b32 v225, s22, v0
    v_lshlrev_b32 v225, 4, v225
    s_lshl_b32 s22, s3, 12
    s_lshl_b32 s23, s20, 15
    s_add_u32 s23, s23, s22
    s_waitcnt lgkmcnt(0)
    s_nop 1
W_1009:
    ds_read_b32 v254, v252 offset:40
    s_waitcnt lgkmcnt(0)
    v_readfirstlane_b32 s61, v254
    s_nop 3
    s_cmp_ge_u32 s61, 4
    s_cbranch_scc1 Wd_1010
    s_sub_u32 s60, s60, 1
    s_cbranch_scc0 W_1009
    s_mov_b32 s60, 0
    v_mov_b32 v254, 263
    v_mov_b32 v255, 0
    buffer_store_dword v254, v255, s[56:59], 0 offen offset:28
    s_nop 3
Wd_1010:
    s_cmp_lg_u32 s3, 0
    s_cbranch_scc1 A2p_1011
    v_mul_u32_u24 v132, 32, v0
    s_and_b32 s63, s2, 7
    s_mul_i32 s63, s63, 2048
    s_add_u32 s63, s63, 15728640
    s_nop 1
Q_1012:
    buffer_load_dwordx4 v[128:131], v132, s[12:15], s63 offen sc1
    s_waitcnt vmcnt(0)
    v_xor_b32 v128, v251, v128
    v_xor_b32 v129, v251, v129
    v_xor_b32 v130, v251, v130
    v_xor_b32 v131, v251, v131
    v_or3_b32 v128, v128, v129, v130
    v_or_b32 v128, v128, v131
    v_cmp_ne_u32 vcc, 0, v128
    s_nop 3
    s_cmp_eq_u64 vcc, 0
    s_cbranch_scc1 Qd_1013
    s_sub_u32 s60, s60, 1
    s_cbranch_scc0 Q_1012
    s_mov_b32 s60, 0
    v_mov_b32 v254, 257
    v_mov_b32 v255, 0
    buffer_store_dword v254, v255, s[56:59], 0 offen offset:4
    s_nop 3
Qd_1013:
    s_mov_b64 exec, 1
    ds_add_u32 v252, v253 offset:24
    s_mov_b64 exec, -1
    s_nop 1
A2p_1011:
W_1014:
    ds_read_b32 v254, v252 offset:24
    s_waitcnt lgkmcnt(0)
    v_readfirstlane_b32 s61, v254
    s_nop 3
    s_cmp_ge_u32 s61, 1
    s_cbranch_scc1 Wd_1015
    s_sub_u32 s60, s60, 1
    s_cbranch_scc0 W_1014
    s_mov_b32 s60, 0
    v_mov_b32 v254, 258
    v_mov_b32 v255, 0
    buffer_store_dword v254, v255, s[56:59], 0 offen offset:8
    s_nop 3
Wd_1015:
    s_add_u32 m0, s22, 0
    s_add_u32 s24, s23, 0
    buffer_load_dwordx4 v14, s[12:15], s24 offen sc1 lds
    s_add_u32 m0, s22, 1024
    s_add_u32 s24, s23, 1024
    buffer_load_dwordx4 v15, s[12:15], s24 offen sc1 lds
    s_add_u32 m0, s22, 2048
    s_add_u32 s24, s23, 2048
    buffer_load_dwordx4 v224, s[12:15], s24 offen sc1 lds
    s_add_u32 m0, s22, 3072
    s_add_u32 s24, s23, 3072
    buffer_load_dwordx4 v225, s[12:15], s24 offen sc1 lds
    s_add_u32 m0, s22, 16384
    s_add_u32 s24, s23, 16384
    buffer_load_dwordx4 v14, s[12:15], s24 offen sc1 lds
    s_add_u32 m0, s22, 17408
    s_add_u32 s24, s23, 17408
    buffer_load_dwordx4 v15, s[12:15], s24 offen sc1 lds
    s_add_u32 m0, s22, 18432
    s_add_u32 s24, s23, 18432
    buffer_load_dwordx4 v224, s[12:15], s24 offen sc1 lds
    s_add_u32 m0, s22, 19456
    s_add_u32 s24, s23, 19456
    buffer_load_dwordx4 v225, s[12:15], s24 offen sc1 lds
    s_add_u32 m0, s22, 32768
    s_add_u32 s24, s23, 1048576
    buffer_load_dwordx4 v14, s[12:15], s24 offen sc1 lds
    s_add_u32 m0, s22, 33792
    s_add_u32 s24, s23, 1049600
    buffer_load_dwordx4 v15, s[12:15], s24 offen sc1 lds
    s_add_u32 m0, s22, 34816
    s_add_u32 s24, s23, 1050624
    buffer_load_dwordx4 v224, s[12:15], s24 offen sc1 lds
    s_add_u32 m0, s22, 35840
    s_add_u32 s24, s23, 1051648
    buffer_load_dwordx4 v225, s[12:15], s24 offen sc1 lds
    s_nop 1
W_1016:
    ds_read_b32 v254, v252 offset:12
    s_waitcnt lgkmcnt(0)
    v_readfirstlane_b32 s61, v254
    s_nop 3
    s_cmp_ge_u32 s61, 4
    s_cbranch_scc1 Wd_1017
    s_sub_u32 s60, s60, 1
    s_cbranch_scc0 W_1016
    s_mov_b32 s60, 0
    v_mov_b32 v254, 259
    v_mov_b32 v255, 0
    buffer_store_dword v254, v255, s[56:59], 0 offen offset:12
    s_nop 3
Wd_1017:
    s_add_u32 m0, s22, 49152
    s_add_u32 s24, s23, 1064960
    buffer_load_dwordx4 v14, s[12:15], s24 offen sc1 lds
    s_add_u32 m0, s22, 50176
    s_add_u32 s24, s23, 1065984
    buffer_load_dwordx4 v15, s[12:15], s24 offen sc1 lds
    s_add_u32 m0, s22, 51200
    s_add_u32 s24, s23, 1067008
    buffer_load_dwordx4 v224, s[12:15], s24 offen sc1 lds
    s_add_u32 m0, s22, 52224
    s_add_u32 s24, s23, 1068032
    buffer_load_dwordx4 v225, s[12:15], s24 offen sc1 lds
    v_lshrrev_b32 v3, 2, v0
    v_lshlrev_b32 v3, 6, v3
    v_add_u32 v3, s20, v3
    v_and_b32 v4, 3, v0
    v_xor_b32 v4, v4, v1
    v_lshlrev_b32 v4, 4, v4
    s_lshl_b32 s22, s21, 6
    v_add_u32 v4, s22, v4
    s_lshl_b32 s23, s3, 11
    s_add_u32 s23, s23, 131072
    s_cmp_ge_u32 s3, 2
    s_cselect_b64 vcc, -1, 0
    v_add_u32 v5, 0, v3
    v_sub_u32 v6, 2048, v5
    v_and_b32 v6, 2047, v6
    v_cndmask_b32 v5, v5, v6, vcc
    v_mul_u32_u24 v5, 514, v5
    v_add_u32 v246, v5, v4
    v_add_u32 v5, 1024, v3
    v_sub_u32 v6, 2048, v5
    v_and_b32 v6, 2047, v6
    v_cndmask_b32 v5, v5, v6, vcc
    v_mul_u32_u24 v5, 514, v5
    v_add_u32 v247, v5, v4
    s_add_u32 s24, s3, 1
    s_bitcmp1_b32 s24, 1
    s_nop 2
    s_cbranch_scc1 A2wi_1018
    s_add_u32 m0, s23, 0
    s_nop 0
    buffer_load_dwordx4 v246, s[44:47], 0 offen lds
    s_add_u32 m0, s23, 1024
    s_nop 0
    buffer_load_dwordx4 v247, s[44:47], 0 offen lds
    s_branch A2we_1019
A2wi_1018:
    s_add_u32 m0, s23, 0
    s_nop 0
    buffer_load_dwordx4 v246, s[8:11], 0 offen lds
    s_add_u32 m0, s23, 1024
    s_nop 0
    buffer_load_dwordx4 v247, s[8:11], 0 offen lds
    s_nop 1
A2we_1019:
    s_cmp_lg_u32 s20, 0
    s_cbranch_scc1 A2w2_1020
    s_mov_b32 s25, 32
    v_lshrrev_b32 v3, 2, v0
    v_lshlrev_b32 v3, 6, v3
    v_add_u32 v3, s25, v3
    v_and_b32 v4, 3, v0
    v_xor_b32 v4, v4, v1
    v_lshlrev_b32 v4, 4, v4
    s_lshl_b32 s22, s21, 6
    v_add_u32 v4, s22, v4
    s_lshl_b32 s23, s3, 11
    s_add_u32 s23, s23, 139264
    s_cmp_ge_u32 s3, 2
    s_cselect_b64 vcc, -1, 0
    v_add_u32 v5, 0, v3
    v_sub_u32 v6, 2048, v5
    v_and_b32 v6, 2047, v6
    v_cndmask_b32 v5, v5, v6, vcc
    v_mul_u32_u24 v5, 514, v5
    v_add_u32 v246, v5, v4
    v_add_u32 v5, 1024, v3
    v_sub_u32 v6, 2048, v5
    v_and_b32 v6, 2047, v6
    v_cndmask_b32 v5, v5, v6, vcc
    v_mul_u32_u24 v5, 514, v5
    v_add_u32 v247, v5, v4
    s_add_u32 s24, s3, 1
    s_bitcmp1_b32 s24, 1
    s_nop 2
    s_cbranch_scc1 A2wi_1021
    s_add_u32 m0, s23, 0
    s_nop 0
    buffer_load_dwordx4 v246, s[44:47], 0 offen lds
    s_add_u32 m0, s23, 1024
    s_nop 0
    buffer_load_dwordx4 v247, s[44:47], 0 offen lds
    s_branch A2we_1022
A2wi_1021:
    s_add_u32 m0, s23, 0
    s_nop 0
    buffer_load_dwordx4 v246, s[8:11], 0 offen lds
    s_add_u32 m0, s23, 1024
    s_nop 0
    buffer_load_dwordx4 v247, s[8:11], 0 offen lds
    s_nop 1
A2we_1022:
A2w2_1020:
    s_cmp_lg_u32 s20, 0
    s_cbranch_scc1 Uw_1023
    s_waitcnt vmcnt(4)
    s_branch Uw_1024
    s_nop 1
Uw_1023:
    s_waitcnt vmcnt(2)
    s_nop 1
Uw_1024:
    s_mov_b64 exec, 1
    ds_add_u32 v252, v253 offset:0
    s_mov_b64 exec, -1
    s_nop 1
W_1025:
    ds_read_b32 v254, v252 offset:0
    s_waitcnt lgkmcnt(0)
    v_readfirstlane_b32 s61, v254
    s_nop 3
    s_cmp_ge_u32 s61, 4
    s_cbranch_scc1 Wd_1026
    s_sub_u32 s60, s60, 1
    s_cbranch_scc0 W_1025
    s_mov_b32 s60, 0
    v_mov_b32 v254, 256
    v_mov_b32 v255, 0
    buffer_store_dword v254, v255, s[56:59], 0 offen offset:0
    s_nop 3
Wd_1026:
    s_or_b32 s22, s21, s3
    s_cmp_lg_u32 s22, 0
    s_nop 1
    s_cbranch_scc1 A2fi_1027
    v_and_b32 v3, 31, v0
    v_lshlrev_b32 v3, 6, v3
    v_add_u32 v3, s20, v3
    v_sub_u32 v4, 2048, v3
    v_and_b32 v4, 2047, v4
    v_lshrrev_b32 v5, 5, v0
    v_lshlrev_b32 v5, 9, v5
    v_mul_u32_u24 v3, 514, v3
    v_add_u32 v3, v3, v5
    v_mul_u32_u24 v4, 514, v4
    v_add_u32 v4, v4, v5
    v_mov_b32 v240, 0
    v_mov_b32 v241, 0
    v_mov_b32 v242, 0
    v_mov_b32 v243, 0
    buffer_load_short_d16_hi v240, v3, s[44:47], 0 offen
    buffer_load_short_d16_hi v241, v4, s[44:47], 0 offen
    buffer_load_short_d16_hi v242, v3, s[8:11], 0 offen
    buffer_load_short_d16_hi v243, v4, s[8:11], 0 offen
    s_nop 1
A2fi_1027:
    s_cmp_lg_u32 s20, 0
    s_nop 1
    s_cbranch_scc1 A2f2_1028
    s_or_b32 s22, s21, s3
    s_cmp_lg_u32 s22, 0
    s_nop 1
    s_cbranch_scc1 A2fi_1029
    v_and_b32 v3, 31, v0
    v_lshlrev_b32 v3, 6, v3
    v_add_u32 v3, 32, v3
    v_sub_u32 v4, 2048, v3
    v_and_b32 v4, 2047, v4
    v_lshrrev_b32 v5, 5, v0
    v_lshlrev_b32 v5, 9, v5
    v_mul_u32_u24 v3, 514, v3
    v_add_u32 v3, v3, v5
    v_mul_u32_u24 v4, 514, v4
    v_add_u32 v4, v4, v5
    v_mov_b32 v244, 0
    v_mov_b32 v245, 0
    v_mov_b32 v246, 0
    v_mov_b32 v247, 0
    buffer_load_short_d16_hi v244, v3, s[44:47], 0 offen
    buffer_load_short_d16_hi v245, v4, s[44:47], 0 offen
    buffer_load_short_d16_hi v246, v3, s[8:11], 0 offen
    buffer_load_short_d16_hi v247, v4, s[8:11], 0 offen
    s_nop 1
A2fi_1029:
A2f2_1028:
    ds_read_b128 v[128:131], v9 offset:0
    ds_read_b128 v[132:135], v9 offset:16384
    ds_read_b128 v[136:139], v9 offset:32768
    ds_read_b128 v[140:143], v9 offset:49152
    ds_read_b128 v[144:147], v10 offset:0
    ds_read_b128 v[148:151], v10 offset:16384
    ds_read_b128 v[152:155], v10 offset:32768
    ds_read_b128 v[156:159], v10 offset:49152
    s_waitcnt lgkmcnt(7)
    v_mfma_f32_16x16x32_bf16 v[160:163], v[128:131], v[64:67], 0
    ds_read_b128 v[128:131], v11 offset:0
    s_waitcnt lgkmcnt(7)
    v_mfma_f32_16x16x32_bf16 v[164:167], v[132:135], v[64:67], 0
    ds_read_b128 v[132:135], v11 offset:16384
    s_waitcnt lgkmcnt(7)
    v_mfma_f32_16x16x32_bf16 v[168:171], v[136:139], v[64:67], 0
    ds_read_b128 v[136:139], v11 offset:32768
    s_waitcnt lgkmcnt(7)
    v_mfma_f32_16x16x32_bf16 v[172:175], v[140:143], v[64:67], 0
    ds_read_b128 v[140:143], v11 offset:49152
    s_waitcnt lgkmcnt(7)
    v_mfma_f32_16x16x32_bf16 v[160:163], v[144:147], v[68:71], v[160:163]
    ds_read_b128 v[144:147], v12 offset:0
    s_waitcnt lgkmcnt(7)
    v_mfma_f32_16x16x32_bf16 v[164:167], v[148:151], v[68:71], v[164:167]
    ds_read_b128 v[148:151], v12 offset:16384
    s_waitcnt lgkmcnt(7)
    v_mfma_f32_16x16x32_bf16 v[168:171], v[152:155], v[68:71], v[168:171]
    ds_read_b128 v[152:155], v12 offset:32768
    s_waitcnt lgkmcnt(7)
    v_mfma_f32_16x16x32_bf16 v[172:175], v[156:159], v[68:71], v[172:175]
    ds_read_b128 v[156:159], v12 offset:49152
    s_waitcnt lgkmcnt(7)
    v_mfma_f32_16x16x32_bf16 v[160:163], v[128:131], v[72:75], v[160:163]
    ds_read_b128 v[128:131], v9 offset:256
    s_waitcnt lgkmcnt(7)
    v_mfma_f32_16x16x32_bf16 v[164:167], v[132:135], v[72:75], v[164:167]
    ds_read_b128 v[132:135], v9 offset:16640
    s_waitcnt lgkmcnt(7)
    v_mfma_f32_16x16x32_bf16 v[168:171], v[136:139], v[72:75], v[168:171]
    ds_read_b128 v[136:139], v9 offset:33024
    s_waitcnt lgkmcnt(7)
    v_mfma_f32_16x16x32_bf16 v[172:175], v[140:143], v[72:75], v[172:175]
    ds_read_b128 v[140:143], v9 offset:49408
    s_waitcnt lgkmcnt(7)
    v_mfma_f32_16x16x32_bf16 v[160:163], v[144:147], v[76:79], v[160:163]
    ds_read_b128 v[144:147], v10 offset:256
    s_waitcnt lgkmcnt(7)
    v_mfma_f32_16x16x32_bf16 v[164:167], v[148:151], v[76:79], v[164:167]
    ds_read_b128 v[148:151], v10 offset:16640
    s_waitcnt lgkmcnt(7)
    v_mfma_f32_16x16x32_bf16 v[168:171], v[152:155], v[76:79], v[168:171]
    ds_read_b128 v[152:155], v10 offset:33024
    s_waitcnt lgkmcnt(7)
    v_mfma_f32_16x16x32_bf16 v[172:175], v[156:159], v[76:79], v[172:175]
    ds_read_b128 v[156:159], v10 offset:49408
    s_waitcnt lgkmcnt(7)
    v_mfma_f32_16x16x32_bf16 v[160:163], v[128:131], v[80:83], v[160:163]
    ds_read_b128 v[128:131], v11 offset:256
    s_waitcnt lgkmcnt(7)
    v_mfma_f32_16x16x32_bf16 v[164:167], v[132:135], v[80:83], v[164:167]
    ds_read_b128 v[132:135], v11 offset:16640
    s_waitcnt lgkmcnt(7)
    v_mfma_f32_16x16x32_bf16 v[168:171], v[136:139], v[80:83], v[168:171]
    ds_read_b128 v[136:139], v11 offset:33024
    s_waitcnt lgkmcnt(7)
    v_mfma_f32_16x16x32_bf16 v[172:175], v[140:143], v[80:83], v[172:175]
    ds_read_b128 v[140:143], v11 offset:49408
    s_waitcnt lgkmcnt(7)
    v_mfma_f32_16x16x32_bf16 v[160:163], v[144:147], v[84:87], v[160:163]
    ds_read_b128 v[144:147], v12 offset:256
    s_waitcnt lgkmcnt(7)
    v_mfma_f32_16x16x32_bf16 v[164:167], v[148:151], v[84:87], v[164:167]
    ds_read_b128 v[148:151], v12 offset:16640
    s_waitcnt lgkmcnt(7)
    v_mfma_f32_16x16x32_bf16 v[168:171], v[152:155], v[84:87], v[168:171]
    ds_read_b128 v[152:155], v12 offset:33024
    s_waitcnt lgkmcnt(7)
    v_mfma_f32_16x16x32_bf16 v[172:175], v[156:159], v[84:87], v[172:175]
    ds_read_b128 v[156:159], v12 offset:49408
    s_waitcnt lgkmcnt(7)
    v_mfma_f32_16x16x32_bf16 v[160:163], v[128:131], v[88:91], v[160:163]
    ds_read_b128 v[128:131], v9 offset:512
    s_waitcnt lgkmcnt(7)
    v_mfma_f32_16x16x32_bf16 v[164:167], v[132:135], v[88:91], v[164:167]
    ds_read_b128 v[132:135], v9 offset:16896
    s_waitcnt lgkmcnt(7)
    v_mfma_f32_16x16x32_bf16 v[168:171], v[136:139], v[88:91], v[168:171]
    ds_read_b128 v[136:139], v9 offset:33280
    s_waitcnt lgkmcnt(7)
    v_mfma_f32_16x16x32_bf16 v[172:175], v[140:143], v[88:91], v[172:175]
    ds_read_b128 v[140:143], v9 offset:49664
    s_waitcnt lgkmcnt(7)
    v_mfma_f32_16x16x32_bf16 v[160:163], v[144:147], v[92:95], v[160:163]
    ds_read_b128 v[144:147], v10 offset:512
    s_waitcnt lgkmcnt(7)
    v_mfma_f32_16x16x32_bf16 v[164:167], v[148:151], v[92:95], v[164:167]
    ds_read_b128 v[148:151], v10 offset:16896
    s_waitcnt lgkmcnt(7)
    v_mfma_f32_16x16x32_bf16 v[168:171], v[152:155], v[92:95], v[168:171]
    ds_read_b128 v[152:155], v10 offset:33280
    s_waitcnt lgkmcnt(7)
    v_mfma_f32_16x16x32_bf16 v[172:175], v[156:159], v[92:95], v[172:175]
    ds_read_b128 v[156:159], v10 offset:49664
    s_waitcnt lgkmcnt(7)
    v_mfma_f32_16x16x32_bf16 v[160:163], v[128:131], v[96:99], v[160:163]
    ds_read_b128 v[128:131], v11 offset:512
    s_waitcnt lgkmcnt(7)
    v_mfma_f32_16x16x32_bf16 v[164:167], v[132:135], v[96:99], v[164:167]
    ds_read_b128 v[132:135], v11 offset:16896
    s_waitcnt lgkmcnt(7)
    v_mfma_f32_16x16x32_bf16 v[168:171], v[136:139], v[96:99], v[168:171]
    ds_read_b128 v[136:139], v11 offset:33280
    s_waitcnt lgkmcnt(7)
    v_mfma_f32_16x16x32_bf16 v[172:175], v[140:143], v[96:99], v[172:175]
    ds_read_b128 v[140:143], v11 offset:49664
    s_waitcnt lgkmcnt(7)
    v_mfma_f32_16x16x32_bf16 v[160:163], v[144:147], v[100:103], v[160:163]
    ds_read_b128 v[144:147], v12 offset:512
    s_waitcnt lgkmcnt(7)
    v_mfma_f32_16x16x32_bf16 v[164:167], v[148:151], v[100:103], v[164:167]
    ds_read_b128 v[148:151], v12 offset:16896
    s_waitcnt lgkmcnt(7)
    v_mfma_f32_16x16x32_bf16 v[168:171], v[152:155], v[100:103], v[168:171]
    ds_read_b128 v[152:155], v12 offset:33280
    s_waitcnt lgkmcnt(7)
    v_mfma_f32_16x16x32_bf16 v[172:175], v[156:159], v[100:103], v[172:175]
    ds_read_b128 v[156:159], v12 offset:49664
    s_waitcnt lgkmcnt(7)
    v_mfma_f32_16x16x32_bf16 v[160:163], v[128:131], v[104:107], v[160:163]
    ds_read_b128 v[128:131], v9 offset:768
    s_waitcnt lgkmcnt(7)
    v_mfma_f32_16x16x32_bf16 v[164:167], v[132:135], v[104:107], v[164:167]
    ds_read_b128 v[132:135], v9 offset:17152
    s_waitcnt lgkmcnt(7)
    v_mfma_f32_16x16x32_bf16 v[168:171], v[136:139], v[104:107], v[168:171]
    ds_read_b128 v[136:139], v9 offset:33536
    s_waitcnt lgkmcnt(7)
    v_mfma_f32_16x16x32_bf16 v[172:175], v[140:143], v[104:107], v[172:175]
    ds_read_b128 v[140:143], v9 offset:49920
    s_waitcnt lgkmcnt(7)
    v_mfma_f32_16x16x32_bf16 v[160:163], v[144:147], v[108:111], v[160:163]
    ds_read_b128 v[144:147], v10 offset:768
    s_waitcnt lgkmcnt(7)
    v_mfma_f32_16x16x32_bf16 v[164:167], v[148:151], v[108:111], v[164:167]
    ds_read_b128 v[148:151], v10 offset:17152
    s_waitcnt lgkmcnt(7)
    v_mfma_f32_16x16x32_bf16 v[168:171], v[152:155], v[108:111], v[168:171]
    ds_read_b128 v[152:155], v10 offset:33536
    s_waitcnt lgkmcnt(7)
    v_mfma_f32_16x16x32_bf16 v[172:175], v[156:159], v[108:111], v[172:175]
    ds_read_b128 v[156:159], v10 offset:49920
    s_waitcnt lgkmcnt(7)
    v_mfma_f32_16x16x32_bf16 v[160:163], v[128:131], v[112:115], v[160:163]
    ds_read_b128 v[128:131], v11 offset:768
    s_waitcnt lgkmcnt(7)
    v_mfma_f32_16x16x32_bf16 v[164:167], v[132:135], v[112:115], v[164:167]
    ds_read_b128 v[132:135], v11 offset:17152
    s_waitcnt lgkmcnt(7)
    v_mfma_f32_16x16x32_bf16 v[168:171], v[136:139], v[112:115], v[168:171]
    ds_read_b128 v[136:139], v11 offset:33536
    s_waitcnt lgkmcnt(7)
    v_mfma_f32_16x16x32_bf16 v[172:175], v[140:143], v[112:115], v[172:175]
    ds_read_b128 v[140:143], v11 offset:49920
    s_waitcnt lgkmcnt(7)
    v_mfma_f32_16x16x32_bf16 v[160:163], v[144:147], v[116:119], v[160:163]
    ds_read_b128 v[144:147], v12 offset:768
    s_waitcnt lgkmcnt(7)
    v_mfma_f32_16x16x32_bf16 v[164:167], v[148:151], v[116:119], v[164:167]
    ds_read_b128 v[148:151], v12 offset:17152
    s_waitcnt lgkmcnt(7)
    v_mfma_f32_16x16x32_bf16 v[168:171], v[152:155], v[116:119], v[168:171]
    ds_read_b128 v[152:155], v12 offset:33536
    s_waitcnt lgkmcnt(7)
    v_mfma_f32_16x16x32_bf16 v[172:175], v[156:159], v[116:119], v[172:175]
    ds_read_b128 v[156:159], v12 offset:49920
    s_waitcnt lgkmcnt(7)
    v_mfma_f32_16x16x32_bf16 v[160:163], v[128:131], v[120:123], v[160:163]
    s_waitcnt lgkmcnt(6)
    v_mfma_f32_16x16x32_bf16 v[164:167], v[132:135], v[120:123], v[164:167]
    s_waitcnt lgkmcnt(5)
    v_mfma_f32_16x16x32_bf16 v[168:171], v[136:139], v[120:123], v[168:171]
    s_waitcnt lgkmcnt(4)
    v_mfma_f32_16x16x32_bf16 v[172:175], v[140:143], v[120:123], v[172:175]
    s_waitcnt lgkmcnt(3)
    v_mfma_f32_16x16x32_bf16 v[160:163], v[144:147], v[124:127], v[160:163]
    s_waitcnt lgkmcnt(2)
    v_mfma_f32_16x16x32_bf16 v[164:167], v[148:151], v[124:127], v[164:167]
    s_waitcnt lgkmcnt(1)
    v_mfma_f32_16x16x32_bf16 v[168:171], v[152:155], v[124:127], v[168:171]
    s_waitcnt lgkmcnt(0)
    v_mfma_f32_16x16x32_bf16 v[172:175], v[156:159], v[124:127], v[172:175]
    s_waitcnt vmcnt(0)
    s_mov_b64 exec, 1
    ds_add_u32 v252, v253 offset:0
    s_mov_b64 exec, -1
    s_nop 3
W_1030:
    ds_read_b32 v254, v252 offset:0
    s_waitcnt lgkmcnt(0)
    v_readfirstlane_b32 s61, v254
    s_nop 3
    s_cmp_ge_u32 s61, 8
    s_cbranch_scc1 Wd_1031
    s_sub_u32 s60, s60, 1
    s_cbranch_scc0 W_1030
    s_mov_b32 s60, 0
    v_mov_b32 v254, 256
    v_mov_b32 v255, 0
    buffer_store_dword v254, v255, s[56:59], 0 offen offset:0
    s_nop 3
Wd_1031:
    v_and_b32 v3, 1, v2
    v_lshlrev_b32 v3, 12, v3
    v_lshl_add_u32 v3, v1, 8, v3
    v_xor_b32 v4, s3, v1
    v_lshl_add_u32 v3, v4, 4, v3
    v_lshrrev_b32 v4, 1, v2
    v_lshl_add_u32 v3, v4, 1, v3
    v_add_u32 v3, 131072, v3
    v_mov_b32 v208, 0
    v_mov_b32 v209, 0
    v_mov_b32 v210, 0
    v_mov_b32 v211, 0
    v_mov_b32 v212, 0
    v_mov_b32 v213, 0
    v_mov_b32 v214, 0
    v_mov_b32 v215, 0
    v_mov_b32 v216, 0
    v_mov_b32 v217, 0
    v_mov_b32 v218, 0
    v_mov_b32 v219, 0
    v_mov_b32 v220, 0
    v_mov_b32 v221, 0
    v_mov_b32 v222, 0
    v_mov_b32 v223, 0
    ds_read_u16_d16_hi v208, v3 offset:0
    ds_read_u16_d16_hi v209, v3 offset:64
    ds_read_u16_d16_hi v210, v3 offset:128
    ds_read_u16_d16_hi v211, v3 offset:192
    ds_read_u16_d16_hi v212, v3 offset:1024
    ds_read_u16_d16_hi v213, v3 offset:1088
    ds_read_u16_d16_hi v214, v3 offset:1152
    ds_read_u16_d16_hi v215, v3 offset:1216
    ds_read_u16_d16_hi v216, v3 offset:2048
    ds_read_u16_d16_hi v217, v3 offset:2112
    ds_read_u16_d16_hi v218, v3 offset:2176
    ds_read_u16_d16_hi v219, v3 offset:2240
    ds_read_u16_d16_hi v220, v3 offset:3072
    ds_read_u16_d16_hi v221, v3 offset:3136
    ds_read_u16_d16_hi v222, v3 offset:3200
    ds_read_u16_d16_hi v223, v3 offset:3264
    s_or_b32 s22, s21, s3
    s_cmp_lg_u32 s22, 0
    s_nop 1
    s_cbranch_scc1 A2fx_1032
    v_fma_f32 v240, v241, s26, v240
    v_fma_f32 v242, -v243, s26, v242
    v_lshlrev_b32 v3, 2, v0
    v_add_u32 v3, 147456, v3
    ds_write_b32 v3, v240
    ds_write_b32 v3, v242 offset:256
    v_lshlrev_b32 v3, 7, v2
    v_lshl_add_u32 v3, v1, 4, v3
    v_add_u32 v3, 147456, v3
    s_waitcnt lgkmcnt(0)
    s_mov_b32 exec_lo, 0x00030003
    s_mov_b32 exec_hi, 0x00030003
    ds_read_b128 v[208:211], v3 offset:0
    ds_read_b128 v[212:215], v3 offset:64
    ds_read_b128 v[216:219], v3 offset:256
    ds_read_b128 v[220:223], v3 offset:320
    s_waitcnt lgkmcnt(0)
    s_mov_b64 exec, -1
    s_nop 1
A2fx_1032:
    s_cmp_lg_u32 s20, 0
    s_nop 1
    s_cbranch_scc1 A2s2_1033
    v_and_b32 v3, 1, v2
    v_lshlrev_b32 v3, 12, v3
    v_lshl_add_u32 v3, v1, 8, v3
    v_xor_b32 v4, s3, v1
    v_lshl_add_u32 v3, v4, 4, v3
    v_lshrrev_b32 v4, 1, v2
    v_lshl_add_u32 v3, v4, 1, v3
    v_add_u32 v3, 139264, v3
    v_mov_b32 v48, 0
    v_mov_b32 v49, 0
    v_mov_b32 v50, 0
    v_mov_b32 v51, 0
    v_mov_b32 v52, 0
    v_mov_b32 v53, 0
    v_mov_b32 v54, 0
    v_mov_b32 v55, 0
    v_mov_b32 v56, 0
    v_mov_b32 v57, 0
    v_mov_b32 v58, 0
    v_mov_b32 v59, 0
    v_mov_b32 v60, 0
    v_mov_b32 v61, 0
    v_mov_b32 v62, 0
    v_mov_b32 v63, 0
    ds_read_u16_d16_hi v48, v3 offset:0
    ds_read_u16_d16_hi v49, v3 offset:64
    ds_read_u16_d16_hi v50, v3 offset:128
    ds_read_u16_d16_hi v51, v3 offset:192
    ds_read_u16_d16_hi v52, v3 offset:1024
    ds_read_u16_d16_hi v53, v3 offset:1088
    ds_read_u16_d16_hi v54, v3 offset:1152
    ds_read_u16_d16_hi v55, v3 offset:1216
    ds_read_u16_d16_hi v56, v3 offset:2048
    ds_read_u16_d16_hi v57, v3 offset:2112
    ds_read_u16_d16_hi v58, v3 offset:2176
    ds_read_u16_d16_hi v59, v3 offset:2240
    ds_read_u16_d16_hi v60, v3 offset:3072
    ds_read_u16_d16_hi v61, v3 offset:3136
    ds_read_u16_d16_hi v62, v3 offset:3200
    ds_read_u16_d16_hi v63, v3 offset:3264
    s_or_b32 s22, s21, s3
    s_cmp_lg_u32 s22, 0
    s_nop 1
    s_cbranch_scc1 A2fx_1034
    v_fma_f32 v244, v245, 0, v244
    v_fma_f32 v246, -v247, 0, v246
    v_lshlrev_b32 v3, 2, v0
    v_add_u32 v3, 147456, v3
    ds_write_b32 v3, v244
    ds_write_b32 v3, v246 offset:256
    v_lshlrev_b32 v3, 7, v2
    v_lshl_add_u32 v3, v1, 4, v3
    v_add_u32 v3, 147456, v3
    s_waitcnt lgkmcnt(0)
    s_mov_b32 exec_lo, 0x00030003
    s_mov_b32 exec_hi, 0x00030003
    ds_read_b128 v[48:51], v3 offset:0
    ds_read_b128 v[52:55], v3 offset:64
    ds_read_b128 v[56:59], v3 offset:256
    ds_read_b128 v[60:63], v3 offset:320
    s_waitcnt lgkmcnt(0)
    s_mov_b64 exec, -1
    s_nop 1
A2fx_1034:
A2s2_1033:
    s_mov_b32 s27, 0
    s_cmp_lg_u32 s20, 0
    s_nop 1
    s_cbranch_scc1 A2loop_1035
    v_mov_b32 v226, v168
    v_mov_b32 v168, 0
    v_mov_b32 v227, v169
    v_mov_b32 v169, 0
    v_mov_b32 v228, v170
    v_mov_b32 v170, 0
    v_mov_b32 v229, v171
    v_mov_b32 v171, 0
    v_mov_b32 v230, v172
    v_mov_b32 v172, 0
    v_mov_b32 v231, v173
    v_mov_b32 v173, 0
    v_mov_b32 v232, v174
    v_mov_b32 v174, 0
    v_mov_b32 v233, v175
    v_mov_b32 v175, 0
    s_nop 4
A2loop_1035:
    v_mov_b32 v128, v168
    v_mov_b32 v129, v169
    v_mov_b32 v130, v170
    v_mov_b32 v131, v171
    v_mov_b32 v132, v172
    v_mov_b32 v133, v173
    v_mov_b32 v134, v174
    v_mov_b32 v135, v175
    v_fmac_f32_dpp v128, v160, v7 quad_perm:[1,0,3,2] row_mask:0xf bank_mask:0xf
    v_fmac_f32_dpp v129, v161, v7 quad_perm:[1,0,3,2] row_mask:0xf bank_mask:0xf
    v_fmac_f32_dpp v130, v162, v7 quad_perm:[1,0,3,2] row_mask:0xf bank_mask:0xf
    v_fmac_f32_dpp v131, v163, v7 quad_perm:[1,0,3,2] row_mask:0xf bank_mask:0xf
    v_fmac_f32_dpp v132, v164, v7 quad_perm:[1,0,3,2] row_mask:0xf bank_mask:0xf
    v_fmac_f32_dpp v133, v165, v7 quad_perm:[1,0,3,2] row_mask:0xf bank_mask:0xf
    v_fmac_f32_dpp v134, v166, v7 quad_perm:[1,0,3,2] row_mask:0xf bank_mask:0xf
    v_fmac_f32_dpp v135, v167, v7 quad_perm:[1,0,3,2] row_mask:0xf bank_mask:0xf
    v_fmac_f32_dpp v160, v168, v8 quad_perm:[1,0,3,2] row_mask:0xf bank_mask:0xf
    v_fmac_f32_dpp v161, v169, v8 quad_perm:[1,0,3,2] row_mask:0xf bank_mask:0xf
    v_fmac_f32_dpp v162, v170, v8 quad_perm:[1,0,3,2] row_mask:0xf bank_mask:0xf
    v_fmac_f32_dpp v163, v171, v8 quad_perm:[1,0,3,2] row_mask:0xf bank_mask:0xf
    v_fmac_f32_dpp v164, v172, v8 quad_perm:[1,0,3,2] row_mask:0xf bank_mask:0xf
    v_fmac_f32_dpp v165, v173, v8 quad_perm:[1,0,3,2] row_mask:0xf bank_mask:0xf
    v_fmac_f32_dpp v166, v174, v8 quad_perm:[1,0,3,2] row_mask:0xf bank_mask:0xf
    v_fmac_f32_dpp v167, v175, v8 quad_perm:[1,0,3,2] row_mask:0xf bank_mask:0xf
    v_cvt_pk_bf16_f32 v140, -v128, -v129
    v_cvt_pk_bf16_f32 v136, v160, v161
    v_cvt_pk_bf16_f32 v144, -v160, -v161
    v_cvt_pk_bf16_f32 v141, -v130, -v131
    v_cvt_pk_bf16_f32 v137, v162, v163
    v_cvt_pk_bf16_f32 v145, -v162, -v163
    v_cvt_pk_bf16_f32 v142, -v132, -v133
    v_cvt_pk_bf16_f32 v138, v164, v165
    v_cvt_pk_bf16_f32 v146, -v164, -v165
    v_cvt_pk_bf16_f32 v143, -v134, -v135
    v_cvt_pk_bf16_f32 v139, v166, v167
    v_cvt_pk_bf16_f32 v147, -v166, -v167
    s_nop 0
    v_mfma_f32_16x16x32_bf16 v[160:163], v[176:179], v[136:139], 0
    v_mfma_f32_16x16x32_bf16 v[168:171], v[176:179], v[140:143], 0
    v_mfma_f32_16x16x32_bf16 v[164:167], v[180:183], v[136:139], 0
    v_mfma_f32_16x16x32_bf16 v[172:175], v[180:183], v[140:143], 0
    v_mfma_f32_16x16x32_bf16 v[160:163], v[184:187], v[140:143], v[160:163]
    v_mfma_f32_16x16x32_bf16 v[168:171], v[184:187], v[144:147], v[168:171]
    v_mfma_f32_16x16x32_bf16 v[164:167], v[188:191], v[140:143], v[164:167]
    v_mfma_f32_16x16x32_bf16 v[172:175], v[188:191], v[144:147], v[172:175]
    s_waitcnt lgkmcnt(0)
    s_nop 3
    v_pk_mul_f32 v[128:129], v[160:161], v[208:209]
    v_pk_mul_f32 v[136:137], v[160:161], v[216:217]
    v_pk_mul_f32 v[130:131], v[162:163], v[210:211]
    v_pk_mul_f32 v[138:139], v[162:163], v[218:219]
    v_pk_mul_f32 v[132:133], v[164:165], v[212:213]
    v_pk_mul_f32 v[140:141], v[164:165], v[220:221]
    v_pk_mul_f32 v[134:135], v[166:167], v[214:215]
    v_pk_mul_f32 v[142:143], v[166:167], v[222:223]
    v_pk_fma_f32 v[128:129], v[168:169], v[216:217], v[128:129] neg_lo:[1,0,0] neg_hi:[1,0,0]
    v_pk_fma_f32 v[136:137], v[168:169], v[208:209], v[136:137]
    v_pk_fma_f32 v[130:131], v[170:171], v[218:219], v[130:131] neg_lo:[1,0,0] neg_hi:[1,0,0]
    v_pk_fma_f32 v[138:139], v[170:171], v[210:211], v[138:139]
    v_pk_fma_f32 v[132:133], v[172:173], v[220:221], v[132:133] neg_lo:[1,0,0] neg_hi:[1,0,0]
    v_pk_fma_f32 v[140:141], v[172:173], v[212:213], v[140:141]
    v_pk_fma_f32 v[134:135], v[174:175], v[222:223], v[134:135] neg_lo:[1,0,0] neg_hi:[1,0,0]
    v_pk_fma_f32 v[142:143], v[174:175], v[214:215], v[142:143]
    v_cvt_pk_bf16_f32 v144, v128, v129
    v_cvt_pk_bf16_f32 v148, v136, v137
    v_cvt_pk_bf16_f32 v152, -v136, -v137
    v_cvt_pk_bf16_f32 v145, v130, v131
    v_cvt_pk_bf16_f32 v149, v138, v139
    v_cvt_pk_bf16_f32 v153, -v138, -v139
    v_cvt_pk_bf16_f32 v146, v132, v133
    v_cvt_pk_bf16_f32 v150, v140, v141
    v_cvt_pk_bf16_f32 v154, -v140, -v141
    v_cvt_pk_bf16_f32 v147, v134, v135
    v_cvt_pk_bf16_f32 v151, v142, v143
    v_cvt_pk_bf16_f32 v155, -v142, -v143
    v_mfma_f32_16x16x32_bf16 v[160:163], v[144:147], v[192:195], 0
    v_mfma_f32_16x16x32_bf16 v[168:171], v[144:147], v[200:203], 0
    v_mfma_f32_16x16x32_bf16 v[164:167], v[144:147], v[196:199], 0
    v_mfma_f32_16x16x32_bf16 v[172:175], v[144:147], v[204:207], 0
    v_mfma_f32_16x16x32_bf16 v[160:163], v[152:155], v[200:203], v[160:163]
    v_mfma_f32_16x16x32_bf16 v[168:171], v[148:151], v[192:195], v[168:171]
    v_mfma_f32_16x16x32_bf16 v[164:167], v[152:155], v[204:207], v[164:167]
    v_mfma_f32_16x16x32_bf16 v[172:175], v[148:151], v[196:199], v[172:175]
    s_nop 4
    v_fma_f32 v128, s26, v161, v160
    v_fma_f32 v129, s26, v169, -v168
    v_fma_f32 v136, s26, v169, v168
    v_fma_f32 v137, -s26, v161, v160
    v_fma_f32 v130, s26, v163, v162
    v_fma_f32 v131, s26, v171, -v170
    v_fma_f32 v138, s26, v171, v170
    v_fma_f32 v139, -s26, v163, v162
    v_fma_f32 v132, s26, v165, v164
    v_fma_f32 v133, s26, v173, -v172
    v_fma_f32 v140, s26, v173, v172
    v_fma_f32 v141, -s26, v165, v164
    v_fma_f32 v134, s26, v167, v166
    v_fma_f32 v135, s26, v175, -v174
    v_fma_f32 v142, s26, v175, v174
    v_fma_f32 v143, -s26, v167, v166
    s_or_b32 s22, s21, s3
    s_cmp_lg_u32 s22, 0
    s_nop 2
    s_cbranch_scc1 A2j0_1039
    s_mov_b64 exec, 0xffff
    v_mul_f32 v128, 0.5, v160
    v_mul_f32 v129, 0.5, v161
    v_mul_f32 v136, 0.5, v168
    v_mul_f32 v137, 0.5, v169
    v_mul_f32 v132, 0.5, v164
    v_mul_f32 v133, 0.5, v165
    v_mul_f32 v140, 0.5, v172
    v_mul_f32 v141, 0.5, v173
    s_mov_b64 exec, -1
    s_nop 3
A2j0_1039:
    v_cvt_pk_bf16_f32 v144, v128, v129
    v_cvt_pk_bf16_f32 v146, v136, v137
    v_cvt_pk_bf16_f32 v145, v130, v131
    v_cvt_pk_bf16_f32 v147, v138, v139
    v_cvt_pk_bf16_f32 v148, v132, v133
    v_cvt_pk_bf16_f32 v150, v140, v141
    v_cvt_pk_bf16_f32 v149, v134, v135
    v_cvt_pk_bf16_f32 v151, v142, v143
    s_cmp_lg_u32 s20, 0
    s_nop 3
    s_cbranch_scc1 A2tail_1038
    s_cmp_lg_u32 s27, 0
    s_cbranch_scc1 A2done_1037
    s_mov_b32 s27, 1
    v_mov_b32 v234, v144
    v_mov_b32 v235, v145
    v_mov_b32 v236, v148
    v_mov_b32 v237, v149
    v_mov_b32 v160, v226
    v_mov_b32 v168, 0
    v_mov_b32 v161, v227
    v_mov_b32 v169, 0
    v_mov_b32 v162, v228
    v_mov_b32 v170, 0
    v_mov_b32 v163, v229
    v_mov_b32 v171, 0
    v_mov_b32 v164, v230
    v_mov_b32 v172, 0
    v_mov_b32 v165, v231
    v_mov_b32 v173, 0
    v_mov_b32 v166, v232
    v_mov_b32 v174, 0
    v_mov_b32 v167, v233
    v_mov_b32 v175, 0
    v_mov_b32 v176, v16
    v_mov_b32 v177, v17
    v_mov_b32 v178, v18
    v_mov_b32 v179, v19
    v_mov_b32 v180, v20
    v_mov_b32 v181, v21
    v_mov_b32 v182, v22
    v_mov_b32 v183, v23
    v_mov_b32 v184, v24
    v_mov_b32 v185, v25
    v_mov_b32 v186, v26
    v_mov_b32 v187, v27
    v_mov_b32 v188, v28
    v_mov_b32 v189, v29
    v_mov_b32 v190, v30
    v_mov_b32 v191, v31
    v_mov_b32 v192, v32
    v_mov_b32 v193, v33
    v_mov_b32 v194, v34
    v_mov_b32 v195, v35
    v_mov_b32 v196, v36
    v_mov_b32 v197, v37
    v_mov_b32 v198, v38
    v_mov_b32 v199, v39
    v_mov_b32 v200, v40
    v_mov_b32 v201, v41
    v_mov_b32 v202, v42
    v_mov_b32 v203, v43
    v_mov_b32 v204, v44
    v_mov_b32 v205, v45
    v_mov_b32 v206, v46
    v_mov_b32 v207, v47
    v_mov_b32 v208, v48
    v_mov_b32 v209, v49
    v_mov_b32 v210, v50
    v_mov_b32 v211, v51
    v_mov_b32 v212, v52
    v_mov_b32 v213, v53
    v_mov_b32 v214, v54
    v_mov_b32 v215, v55
    v_mov_b32 v216, v56
    v_mov_b32 v217, v57
    v_mov_b32 v218, v58
    v_mov_b32 v219, v59
    v_mov_b32 v220, v60
    v_mov_b32 v221, v61
    v_mov_b32 v222, v62
    v_mov_b32 v223, v63
    s_nop 4
    s_branch A2loop_1035
A2done_1037:
    v_mov_b32 v146, v144
    v_mov_b32 v144, v234
    v_mov_b32 v147, v145
    v_mov_b32 v145, v235
    v_mov_b32 v150, v148
    v_mov_b32 v148, v236
    v_mov_b32 v151, v149
    v_mov_b32 v149, v237
    s_nop 4
A2tail_1038:
    v_permlane16_swap_b32 v144, v146
    v_permlane16_swap_b32 v145, v147
    v_permlane16_swap_b32 v148, v150
    v_permlane16_swap_b32 v149, v151
    s_lshl_b32 s22, s20, 11
    s_lshl_b32 s23, s21, 8
    s_add_u32 s22, s22, s23
    s_lshl_b32 s23, s3, 6
    s_add_u32 s22, s22, s23
    s_add_u32 s22, s22, 2097152
    buffer_store_dwordx4 v[144:147], v13, s[12:15], s22 offen sc1
    s_add_u32 s22, s22, 1048576
    buffer_store_dwordx4 v[148:151], v13, s[12:15], s22 offen sc1
    s_waitcnt vmcnt(0)
    s_mov_b64 exec, 1
    ds_add_rtn_u32 v254, v252, v253 offset:16
    s_waitcnt lgkmcnt(0)
    v_readfirstlane_b32 s61, v254
    s_nop 3
    s_cmp_lg_u32 s61, 3
    s_cbranch_scc1 P_1040
    s_lshr_b32 s63, s2, 2
    s_mul_i32 s63, s63, 32
    s_and_b32 s61, s2, 3
    s_lshl_b32 s61, s61, 2
    s_add_u32 s63, s63, s61
    s_add_u32 s63, s63, 15745024
    s_mov_b64 exec, 255
    v_mul_u32_u24 v254, 2048, v0
    buffer_store_dword v251, v254, s[12:15], s63 offen sc1
    s_nop 3
P_1040:
    s_mov_b64 exec, -1
    s_load_dwordx2 s[4:5], s[0:1], 56
    s_lshl_b32 s22, s21, 6
    s_lshl_b32 s23, s3, 4
    s_add_u32 s22, s22, s23
    v_add_u32 v3, s22, v2
    v_cvt_f32_u32 v3, v3
    v_mul_f32 v3, 0x3b000000, v3
    v_lshlrev_b32 v4, 2, v1
    v_cvt_f32_u32 v4, v4
    v_mul_f32 v4, v4, v3
    v_add_f32 v5, 0xbe800000, v4
    v_and_b32 v6, 1, v2
    v_cvt_f32_u32 v6, v6
    v_fma_f32 v6, v6, -2.0, 1.0
    v_mul_f32 v144, 0x41800000, v3
    v_cos_f32 v144, v144
    v_cos_f32 v128, v4
    v_fmamk_f32 v136, v3, 0x41800000, v4
    v_cos_f32 v136, v136
    v_cos_f32 v129, v5
    v_fmamk_f32 v137, v3, 0x41800000, v5
    v_cos_f32 v137, v137
    v_fmamk_f32 v130, v3, 0x3f800000, v4
    v_cos_f32 v130, v130
    v_fmamk_f32 v138, v3, 0x41880000, v4
    v_cos_f32 v138, v138
    v_fmamk_f32 v131, v3, 0x3f800000, v5
    v_cos_f32 v131, v131
    v_fmamk_f32 v139, v3, 0x41880000, v5
    v_cos_f32 v139, v139
    v_fmamk_f32 v132, v3, 0x40000000, v4
    v_cos_f32 v132, v132
    v_fmamk_f32 v140, v3, 0x41900000, v4
    v_cos_f32 v140, v140
    v_fmamk_f32 v133, v3, 0x40000000, v5
    v_cos_f32 v133, v133
    v_fmamk_f32 v141, v3, 0x41900000, v5
    v_cos_f32 v141, v141
    v_fmamk_f32 v134, v3, 0x40400000, v4
    v_cos_f32 v134, v134
    v_fmamk_f32 v142, v3, 0x41980000, v4
    v_cos_f32 v142, v142
    v_fmamk_f32 v135, v3, 0x40400000, v5
    v_cos_f32 v135, v135
    v_fmamk_f32 v143, v3, 0x41980000, v5
    v_cos_f32 v143, v143
    v_add_f32 v144, v144, v144
    v_cmp_eq_u32 vcc, 0, v1
    s_nop 1
    v_cndmask_b32 v145, v129, v6, vcc
    v_cvt_pk_bf16_f32 v64, v128, v145
    v_cvt_pk_bf16_f32 v65, v130, v131
    v_cvt_pk_bf16_f32 v66, v132, v133
    v_cvt_pk_bf16_f32 v67, v134, v135
    v_cvt_pk_bf16_f32 v68, v136, v137
    v_cvt_pk_bf16_f32 v69, v138, v139
    v_cvt_pk_bf16_f32 v70, v140, v141
    v_cvt_pk_bf16_f32 v71, v142, v143
    v_fma_f32 v128, v144, v136, -v128
    v_fma_f32 v129, v144, v137, -v129
    v_fma_f32 v130, v144, v138, -v130
    v_fma_f32 v131, v144, v139, -v131
    v_fma_f32 v132, v144, v140, -v132
    v_fma_f32 v133, v144, v141, -v133
    v_fma_f32 v134, v144, v142, -v134
    v_fma_f32 v135, v144, v143, -v135
    v_cvt_pk_bf16_f32 v72, v128, v129
    v_cvt_pk_bf16_f32 v73, v130, v131
    v_cvt_pk_bf16_f32 v74, v132, v133
    v_cvt_pk_bf16_f32 v75, v134, v135
    v_fma_f32 v136, v144, v128, -v136
    v_fma_f32 v137, v144, v129, -v137
    v_fma_f32 v138, v144, v130, -v138
    v_fma_f32 v139, v144, v131, -v139
    v_fma_f32 v140, v144, v132, -v140
    v_fma_f32 v141, v144, v133, -v141
    v_fma_f32 v142, v144, v134, -v142
    v_fma_f32 v143, v144, v135, -v143
    v_cvt_pk_bf16_f32 v76, v136, v137
    v_cvt_pk_bf16_f32 v77, v138, v139
    v_cvt_pk_bf16_f32 v78, v140, v141
    v_cvt_pk_bf16_f32 v79, v142, v143
    v_fma_f32 v128, v144, v136, -v128
    v_fma_f32 v129, v144, v137, -v129
    v_fma_f32 v130, v144, v138, -v130
    v_fma_f32 v131, v144, v139, -v131
    v_fma_f32 v132, v144, v140, -v132
    v_fma_f32 v133, v144, v141, -v133
    v_fma_f32 v134, v144, v142, -v134
    v_fma_f32 v135, v144, v143, -v135
    v_cvt_pk_bf16_f32 v80, v128, v129
    v_cvt_pk_bf16_f32 v81, v130, v131
    v_cvt_pk_bf16_f32 v82, v132, v133
    v_cvt_pk_bf16_f32 v83, v134, v135
    v_fma_f32 v136, v144, v128, -v136
    v_fma_f32 v137, v144, v129, -v137
    v_fma_f32 v138, v144, v130, -v138
    v_fma_f32 v139, v144, v131, -v139
    v_fma_f32 v140, v144, v132, -v140
    v_fma_f32 v141, v144, v133, -v141
    v_fma_f32 v142, v144, v134, -v142
    v_fma_f32 v143, v144, v135, -v143
    v_cvt_pk_bf16_f32 v84, v136, v137
    v_cvt_pk_bf16_f32 v85, v138, v139
    v_cvt_pk_bf16_f32 v86, v140, v141
    v_cvt_pk_bf16_f32 v87, v142, v143
    v_fma_f32 v128, v144, v136, -v128
    v_fma_f32 v129, v144, v137, -v129
    v_fma_f32 v130, v144, v138, -v130
    v_fma_f32 v131, v144, v139, -v131
    v_fma_f32 v132, v144, v140, -v132
    v_fma_f32 v133, v144, v141, -v133
    v_fma_f32 v134, v144, v142, -v134
    v_fma_f32 v135, v144, v143, -v135
    v_cvt_pk_bf16_f32 v88, v128, v129
    v_cvt_pk_bf16_f32 v89, v130, v131
    v_cvt_pk_bf16_f32 v90, v132, v133
    v_cvt_pk_bf16_f32 v91, v134, v135
    v_fma_f32 v136, v144, v128, -v136
    v_fma_f32 v137, v144, v129, -v137
    v_fma_f32 v138, v144, v130, -v138
    v_fma_f32 v139, v144, v131, -v139
    v_fma_f32 v140, v144, v132, -v140
    v_fma_f32 v141, v144, v133, -v141
    v_fma_f32 v142, v144, v134, -v142
    v_fma_f32 v143, v144, v135, -v143
    v_cvt_pk_bf16_f32 v92, v136, v137
    v_cvt_pk_bf16_f32 v93, v138, v139
    v_cvt_pk_bf16_f32 v94, v140, v141
    v_cvt_pk_bf16_f32 v95, v142, v143
    v_fma_f32 v128, v144, v136, -v128
    v_fma_f32 v129, v144, v137, -v129
    v_fma_f32 v130, v144, v138, -v130
    v_fma_f32 v131, v144, v139, -v131
    v_fma_f32 v132, v144, v140, -v132
    v_fma_f32 v133, v144, v141, -v133
    v_fma_f32 v134, v144, v142, -v134
    v_fma_f32 v135, v144, v143, -v135
    v_cvt_pk_bf16_f32 v96, v128, v129
    v_cvt_pk_bf16_f32 v97, v130, v131
    v_cvt_pk_bf16_f32 v98, v132, v133
    v_cvt_pk_bf16_f32 v99, v134, v135
    v_fma_f32 v136, v144, v128, -v136
    v_fma_f32 v137, v144, v129, -v137
    v_fma_f32 v138, v144, v130, -v138
    v_fma_f32 v139, v144, v131, -v139
    v_fma_f32 v140, v144, v132, -v140
    v_fma_f32 v141, v144, v133, -v141
    v_fma_f32 v142, v144, v134, -v142
    v_fma_f32 v143, v144, v135, -v143
    v_cvt_pk_bf16_f32 v100, v136, v137
    v_cvt_pk_bf16_f32 v101, v138, v139
    v_cvt_pk_bf16_f32 v102, v140, v141
    v_cvt_pk_bf16_f32 v103, v142, v143
    v_fma_f32 v128, v144, v136, -v128
    v_fma_f32 v129, v144, v137, -v129
    v_fma_f32 v130, v144, v138, -v130
    v_fma_f32 v131, v144, v139, -v131
    v_fma_f32 v132, v144, v140, -v132
    v_fma_f32 v133, v144, v141, -v133
    v_fma_f32 v134, v144, v142, -v134
    v_fma_f32 v135, v144, v143, -v135
    v_cvt_pk_bf16_f32 v104, v128, v129
    v_cvt_pk_bf16_f32 v105, v130, v131
    v_cvt_pk_bf16_f32 v106, v132, v133
    v_cvt_pk_bf16_f32 v107, v134, v135
    v_fma_f32 v136, v144, v128, -v136
    v_fma_f32 v137, v144, v129, -v137
    v_fma_f32 v138, v144, v130, -v138
    v_fma_f32 v139, v144, v131, -v139
    v_fma_f32 v140, v144, v132, -v140
    v_fma_f32 v141, v144, v133, -v141
    v_fma_f32 v142, v144, v134, -v142
    v_fma_f32 v143, v144, v135, -v143
    v_cvt_pk_bf16_f32 v108, v136, v137
    v_cvt_pk_bf16_f32 v109, v138, v139
    v_cvt_pk_bf16_f32 v110, v140, v141
    v_cvt_pk_bf16_f32 v111, v142, v143
    v_fma_f32 v128, v144, v136, -v128
    v_fma_f32 v129, v144, v137, -v129
    v_fma_f32 v130, v144, v138, -v130
    v_fma_f32 v131, v144, v139, -v131
    v_fma_f32 v132, v144, v140, -v132
    v_fma_f32 v133, v144, v141, -v133
    v_fma_f32 v134, v144, v142, -v134
    v_fma_f32 v135, v144, v143, -v135
    v_cvt_pk_bf16_f32 v112, v128, v129
    v_cvt_pk_bf16_f32 v113, v130, v131
    v_cvt_pk_bf16_f32 v114, v132, v133
    v_cvt_pk_bf16_f32 v115, v134, v135
    v_fma_f32 v136, v144, v128, -v136
    v_fma_f32 v137, v144, v129, -v137
    v_fma_f32 v138, v144, v130, -v138
    v_fma_f32 v139, v144, v131, -v139
    v_fma_f32 v140, v144, v132, -v140
    v_fma_f32 v141, v144, v133, -v141
    v_fma_f32 v142, v144, v134, -v142
    v_fma_f32 v143, v144, v135, -v143
    v_cvt_pk_bf16_f32 v116, v136, v137
    v_cvt_pk_bf16_f32 v117, v138, v139
    v_cvt_pk_bf16_f32 v118, v140, v141
    v_cvt_pk_bf16_f32 v119, v142, v143
    v_fma_f32 v128, v144, v136, -v128
    v_fma_f32 v129, v144, v137, -v129
    v_fma_f32 v130, v144, v138, -v130
    v_fma_f32 v131, v144, v139, -v131
    v_fma_f32 v132, v144, v140, -v132
    v_fma_f32 v133, v144, v141, -v133
    v_fma_f32 v134, v144, v142, -v134
    v_fma_f32 v135, v144, v143, -v135
    v_cvt_pk_bf16_f32 v120, v128, v129
    v_cvt_pk_bf16_f32 v121, v130, v131
    v_cvt_pk_bf16_f32 v122, v132, v133
    v_cvt_pk_bf16_f32 v123, v134, v135
    v_fma_f32 v136, v144, v128, -v136
    v_fma_f32 v137, v144, v129, -v137
    v_fma_f32 v138, v144, v130, -v138
    v_fma_f32 v139, v144, v131, -v139
    v_fma_f32 v140, v144, v132, -v140
    v_fma_f32 v141, v144, v133, -v141
    v_fma_f32 v142, v144, v134, -v142
    v_fma_f32 v143, v144, v135, -v143
    v_cvt_pk_bf16_f32 v124, v136, v137
    v_cvt_pk_bf16_f32 v125, v138, v139
    v_cvt_pk_bf16_f32 v126, v140, v141
    v_cvt_pk_bf16_f32 v127, v142, v143
    v_lshlrev_b32 v6, 2, v1
    v_cvt_f32_u32 v6, v6
    v_and_b32 v5, 1, v2
    v_cvt_f32_u32 v5, v5
    v_fma_f32 v5, v5, 2.0, -1.0
    v_cmp_eq_u32 vcc, 0, v1
    v_add_u32 v3, 0, v2
    v_cvt_f32_u32 v3, v3
    v_mul_f32 v3, 0x3c800000, v3
    v_mul_f32 v4, v3, v6
    v_cos_f32 v128, v4
    v_sin_f32 v136, v4
    v_fmamk_f32 v145, v3, 0x3f800000, v4
    v_cos_f32 v129, v145
    v_sin_f32 v137, v145
    v_fmamk_f32 v146, v3, 0x40000000, v4
    v_cos_f32 v130, v146
    v_sin_f32 v138, v146
    v_fmamk_f32 v147, v3, 0x40400000, v4
    v_cos_f32 v131, v147
    v_sin_f32 v139, v147
    v_fmamk_f32 v148, v3, 0x41800000, v4
    v_cos_f32 v132, v148
    v_sin_f32 v140, v148
    v_fmamk_f32 v149, v3, 0x41880000, v4
    v_cos_f32 v133, v149
    v_sin_f32 v141, v149
    v_fmamk_f32 v150, v3, 0x41900000, v4
    v_cos_f32 v134, v150
    v_sin_f32 v142, v150
    v_fmamk_f32 v151, v3, 0x41980000, v4
    v_cos_f32 v135, v151
    v_sin_f32 v143, v151
    v_cndmask_b32 v136, v136, v5, vcc
    v_cvt_pk_bf16_f32 v16, v128, v129
    v_cvt_pk_bf16_f32 v20, -v136, -v137
    v_cvt_pk_bf16_f32 v17, v130, v131
    v_cvt_pk_bf16_f32 v21, -v138, -v139
    v_cvt_pk_bf16_f32 v18, v132, v133
    v_cvt_pk_bf16_f32 v22, -v140, -v141
    v_cvt_pk_bf16_f32 v19, v134, v135
    v_cvt_pk_bf16_f32 v23, -v142, -v143
    v_add_u32 v3, 16, v2
    v_cvt_f32_u32 v3, v3
    v_mul_f32 v3, 0x3c800000, v3
    v_mul_f32 v4, v3, v6
    v_cos_f32 v128, v4
    v_sin_f32 v136, v4
    v_fmamk_f32 v145, v3, 0x3f800000, v4
    v_cos_f32 v129, v145
    v_sin_f32 v137, v145
    v_fmamk_f32 v146, v3, 0x40000000, v4
    v_cos_f32 v130, v146
    v_sin_f32 v138, v146
    v_fmamk_f32 v147, v3, 0x40400000, v4
    v_cos_f32 v131, v147
    v_sin_f32 v139, v147
    v_fmamk_f32 v148, v3, 0x41800000, v4
    v_cos_f32 v132, v148
    v_sin_f32 v140, v148
    v_fmamk_f32 v149, v3, 0x41880000, v4
    v_cos_f32 v133, v149
    v_sin_f32 v141, v149
    v_fmamk_f32 v150, v3, 0x41900000, v4
    v_cos_f32 v134, v150
    v_sin_f32 v142, v150
    v_fmamk_f32 v151, v3, 0x41980000, v4
    v_cos_f32 v135, v151
    v_sin_f32 v143, v151
    v_cndmask_b32 v136, v136, v5, vcc
    v_cvt_pk_bf16_f32 v24, v128, v129
    v_cvt_pk_bf16_f32 v28, -v136, -v137
    v_cvt_pk_bf16_f32 v25, v130, v131
    v_cvt_pk_bf16_f32 v29, -v138, -v139
    v_cvt_pk_bf16_f32 v26, v132, v133
    v_cvt_pk_bf16_f32 v30, -v140, -v141
    v_cvt_pk_bf16_f32 v27, v134, v135
    v_cvt_pk_bf16_f32 v31, -v142, -v143
    v_add_u32 v3, 32, v2
    v_cvt_f32_u32 v3, v3
    v_mul_f32 v3, 0x3c800000, v3
    v_mul_f32 v4, v3, v6
    v_cos_f32 v128, v4
    v_sin_f32 v136, v4
    v_fmamk_f32 v145, v3, 0x3f800000, v4
    v_cos_f32 v129, v145
    v_sin_f32 v137, v145
    v_fmamk_f32 v146, v3, 0x40000000, v4
    v_cos_f32 v130, v146
    v_sin_f32 v138, v146
    v_fmamk_f32 v147, v3, 0x40400000, v4
    v_cos_f32 v131, v147
    v_sin_f32 v139, v147
    v_fmamk_f32 v148, v3, 0x41800000, v4
    v_cos_f32 v132, v148
    v_sin_f32 v140, v148
    v_fmamk_f32 v149, v3, 0x41880000, v4
    v_cos_f32 v133, v149
    v_sin_f32 v141, v149
    v_fmamk_f32 v150, v3, 0x41900000, v4
    v_cos_f32 v134, v150
    v_sin_f32 v142, v150
    v_fmamk_f32 v151, v3, 0x41980000, v4
    v_cos_f32 v135, v151
    v_sin_f32 v143, v151
    v_cndmask_b32 v136, v136, v5, vcc
    v_cvt_pk_bf16_f32 v32, v128, v129
    v_cvt_pk_bf16_f32 v36, -v136, -v137
    v_cvt_pk_bf16_f32 v33, v130, v131
    v_cvt_pk_bf16_f32 v37, -v138, -v139
    v_cvt_pk_bf16_f32 v34, v132, v133
    v_cvt_pk_bf16_f32 v38, -v140, -v141
    v_cvt_pk_bf16_f32 v35, v134, v135
    v_cvt_pk_bf16_f32 v39, -v142, -v143
    v_add_u32 v3, 48, v2
    v_cvt_f32_u32 v3, v3
    v_mul_f32 v3, 0x3c800000, v3
    v_mul_f32 v4, v3, v6
    v_cos_f32 v128, v4
    v_sin_f32 v136, v4
    v_fmamk_f32 v145, v3, 0x3f800000, v4
    v_cos_f32 v129, v145
    v_sin_f32 v137, v145
    v_fmamk_f32 v146, v3, 0x40000000, v4
    v_cos_f32 v130, v146
    v_sin_f32 v138, v146
    v_fmamk_f32 v147, v3, 0x40400000, v4
    v_cos_f32 v131, v147
    v_sin_f32 v139, v147
    v_fmamk_f32 v148, v3, 0x41800000, v4
    v_cos_f32 v132, v148
    v_sin_f32 v140, v148
    v_fmamk_f32 v149, v3, 0x41880000, v4
    v_cos_f32 v133, v149
    v_sin_f32 v141, v149
    v_fmamk_f32 v150, v3, 0x41900000, v4
    v_cos_f32 v134, v150
    v_sin_f32 v142, v150
    v_fmamk_f32 v151, v3, 0x41980000, v4
    v_cos_f32 v135, v151
    v_sin_f32 v143, v151
    v_cndmask_b32 v136, v136, v5, vcc
    v_cvt_pk_bf16_f32 v40, v128, v129
    v_cvt_pk_bf16_f32 v44, -v136, -v137
    v_cvt_pk_bf16_f32 v41, v130, v131
    v_cvt_pk_bf16_f32 v45, -v138, -v139
    v_cvt_pk_bf16_f32 v42, v132, v133
    v_cvt_pk_bf16_f32 v46, -v140, -v141
    v_cvt_pk_bf16_f32 v43, v134, v135
    v_cvt_pk_bf16_f32 v47, -v142, -v143
    v_lshlrev_b32 v3, 1, v1
    v_or_b32 v3, 0, v3
    v_xor_b32 v3, v3, v2
    v_lshlrev_b32 v3, 4, v3
    v_lshl_add_u32 v9, v2, 11, v3
    v_lshlrev_b32 v3, 1, v1
    v_or_b32 v3, 8, v3
    v_xor_b32 v3, v3, v2
    v_lshlrev_b32 v3, 4, v3
    v_lshl_add_u32 v10, v2, 11, v3
    v_lshlrev_b32 v3, 1, v1
    v_or_b32 v3, 1, v3
    v_xor_b32 v3, v3, v2
    v_lshlrev_b32 v3, 4, v3
    v_lshl_add_u32 v11, v2, 11, v3
    v_lshlrev_b32 v3, 1, v1
    v_or_b32 v3, 9, v3
    v_xor_b32 v3, v3, v2
    v_lshlrev_b32 v3, 4, v3
    v_lshl_add_u32 v12, v2, 11, v3
    v_and_b32 v3, 1, v1
    v_lshl_add_u32 v3, v3, 4, v2
    v_lshlrev_b32 v3, 15, v3
    v_lshrrev_b32 v4, 1, v1
    v_lshl_add_u32 v13, v4, 4, v3
    v_lshlrev_b32 v3, 8, v1
    v_lshl_add_u32 v3, v2, 4, v3
    s_lshl_b32 s22, s20, 11
    s_add_u32 s22, s22, 10485760
    buffer_load_dwordx4 v[48:51], v3, s[12:15], s22 offen offset:0 sc1
    buffer_load_dwordx4 v[52:55], v3, s[12:15], s22 offen offset:1024 sc1
    s_waitcnt lgkmcnt(0)
    s_and_b32 s5, s5, 0xffff
    s_mov_b32 s6, 1024
    s_mov_b32 s7, 0x20000
    s_lshl_b32 s22, s21, 7
    s_lshl_b32 s23, s3, 5
    s_add_u32 s22, s22, s23
    v_lshlrev_b32 v3, 3, v1
    buffer_load_dwordx2 v[240:241], v3, s[4:7], s22 offen
    s_lshl_b32 s22, s3, 2
    s_add_u32 s22, s22, 0
    v_xor_b32 v14, s22, v0
    v_lshlrev_b32 v14, 4, v14
    s_lshl_b32 s22, s3, 2
    s_add_u32 s22, s22, 1
    v_xor_b32 v15, s22, v0
    v_lshlrev_b32 v15, 4, v15
    s_lshl_b32 s22, s3, 2
    s_add_u32 s22, s22, 2
    v_xor_b32 v224, s22, v0
    v_lshlrev_b32 v224, 4, v224
    s_lshl_b32 s22, s3, 2
    s_add_u32 s22, s22, 3
    v_xor_b32 v225, s22, v0
    v_lshlrev_b32 v225, 4, v225
    s_lshl_b32 s22, s3, 13
    s_lshl_b32 s23, s20, 16
    s_add_u32 s23, s23, s22
    s_add_u32 s23, s23, 2097152
    s_waitcnt vmcnt(0)
    v_lshlrev_b32 v242, 16, v240
    v_and_b32 v243, 0xffff0000, v240
    v_lshlrev_b32 v244, 16, v241
    v_and_b32 v245, 0xffff0000, v241
    v_add_f32 v48, v48, v52
    v_add_f32 v49, v49, v53
    v_add_f32 v50, v50, v54
    v_add_f32 v51, v51, v55
    v_mov_b32 v52, v48
    v_mov_b32 v53, v49
    v_mov_b32 v54, v50
    v_mov_b32 v55, v51
    v_permlane32_swap_b32 v48, v52
    v_permlane32_swap_b32 v49, v53
    v_permlane32_swap_b32 v50, v54
    v_permlane32_swap_b32 v51, v55
    v_add_f32 v48, v48, v52
    v_add_f32 v49, v49, v53
    v_add_f32 v50, v50, v54
    v_add_f32 v51, v51, v55
    v_mov_b32 v52, v48
    v_mov_b32 v53, v49
    v_mov_b32 v54, v50
    v_mov_b32 v55, v51
    v_permlane16_swap_b32 v48, v52
    v_permlane16_swap_b32 v49, v53
    v_permlane16_swap_b32 v50, v54
    v_permlane16_swap_b32 v51, v55
    v_add_f32 v48, v48, v52
    v_add_f32 v49, v49, v53
    v_add_f32 v50, v50, v54
    v_add_f32 v51, v51, v55
    v_mul_f32 v48, 0xbfb8aa3b, v48
    v_mul_f32 v49, 0xbfb8aa3b, v49
    v_mul_f32 v50, 0xbfb8aa3b, v50
    v_mul_f32 v51, 0xbfb8aa3b, v51
    v_exp_f32 v48, v48
    v_exp_f32 v49, v49
    v_exp_f32 v50, v50
    v_exp_f32 v51, v51
    v_add_f32 v48, 1.0, v48
    v_add_f32 v49, 1.0, v49
    v_add_f32 v50, 1.0, v50
    v_add_f32 v51, 1.0, v51
    v_rcp_f32 v48, v48
    v_rcp_f32 v49, v49
    v_rcp_f32 v50, v50
    v_rcp_f32 v51, v51
    v_mul_f32 v200, 0x36000000, v48
    v_mul_f32 v201, 0x36000000, v48
    v_mul_f32 v202, 0x36000000, v49
    v_mul_f32 v203, 0x36000000, v49
    v_mul_f32 v204, 0x36000000, v50
    v_mul_f32 v205, 0x36000000, v50
    v_mul_f32 v206, 0x36000000, v51
    v_mul_f32 v207, 0x36000000, v51
    v_sub_f32 v192, 1.0, v48
    v_sub_f32 v193, 1.0, v48
    v_sub_f32 v194, 1.0, v49
    v_sub_f32 v195, 1.0, v49
    v_sub_f32 v196, 1.0, v50
    v_sub_f32 v197, 1.0, v50
    v_sub_f32 v198, 1.0, v51
    v_sub_f32 v199, 1.0, v51
    v_pk_mul_f32 v[176:177], v[242:243], v[192:193]
    v_pk_mul_f32 v[178:179], v[244:245], v[192:193]
    v_pk_mul_f32 v[180:181], v[242:243], v[194:195]
    v_pk_mul_f32 v[182:183], v[244:245], v[194:195]
    v_pk_mul_f32 v[184:185], v[242:243], v[196:197]
    v_pk_mul_f32 v[186:187], v[244:245], v[196:197]
    v_pk_mul_f32 v[188:189], v[242:243], v[198:199]
    v_pk_mul_f32 v[190:191], v[244:245], v[198:199]
    s_nop 4
    s_cmp_lg_u32 s3, 0
    s_cbranch_scc1 A3p_1041
    v_mul_u32_u24 v132, 32, v0
    s_and_b32 s63, s2, 7
    s_mul_i32 s63, s63, 2048
    s_add_u32 s63, s63, 15745024
    s_nop 1
Q_1042:
    buffer_load_dwordx4 v[128:131], v132, s[12:15], s63 offen sc1
    s_waitcnt vmcnt(0)
    v_xor_b32 v128, v251, v128
    v_xor_b32 v129, v251, v129
    v_xor_b32 v130, v251, v130
    v_xor_b32 v131, v251, v131
    v_or3_b32 v128, v128, v129, v130
    v_or_b32 v128, v128, v131
    v_cmp_ne_u32 vcc, 0, v128
    s_nop 3
    s_cmp_eq_u64 vcc, 0
    s_cbranch_scc1 Qd_1043
    s_sub_u32 s60, s60, 1
    s_cbranch_scc0 Q_1042
    s_mov_b32 s60, 0
    v_mov_b32 v254, 260
    v_mov_b32 v255, 0
    buffer_store_dword v254, v255, s[56:59], 0 offen offset:16
    s_nop 3
Qd_1043:
    s_mov_b64 exec, 1
    ds_add_u32 v252, v253 offset:28
    s_mov_b64 exec, -1
    s_cmp_lg_u32 s2, 0
    s_cbranch_scc1 A3n_1044
    s_mov_b32 s63, 15777792
    v_mov_b32 v254, 0
    s_mov_b64 exec, 1
    buffer_store_dword v251, v254, s[12:15], s63 offen sc1
    s_mov_b64 exec, -1
    s_nop 1
A3n_1044:
A3p_1041:
W_1045:
    ds_read_b32 v254, v252 offset:28
    s_waitcnt lgkmcnt(0)
    v_readfirstlane_b32 s61, v254
    s_nop 3
    s_cmp_ge_u32 s61, 1
    s_cbranch_scc1 Wd_1046
    s_sub_u32 s60, s60, 1
    s_cbranch_scc0 W_1045
    s_mov_b32 s60, 0
    v_mov_b32 v254, 261
    v_mov_b32 v255, 0
    buffer_store_dword v254, v255, s[56:59], 0 offen offset:20
    s_nop 3
Wd_1046:
    s_add_u32 m0, s22, 0
    s_add_u32 s24, s23, 0
    buffer_load_dwordx4 v14, s[12:15], s24 offen sc1 lds
    s_add_u32 m0, s22, 2048
    s_add_u32 s24, s23, 2048
    buffer_load_dwordx4 v15, s[12:15], s24 offen sc1 lds
    s_add_u32 m0, s22, 4096
    s_add_u32 s24, s23, 4096
    buffer_load_dwordx4 v224, s[12:15], s24 offen sc1 lds
    s_add_u32 m0, s22, 6144
    s_add_u32 s24, s23, 6144
    buffer_load_dwordx4 v225, s[12:15], s24 offen sc1 lds
    s_add_u32 m0, s22, 32768
    s_add_u32 s24, s23, 32768
    buffer_load_dwordx4 v14, s[12:15], s24 offen sc1 lds
    s_add_u32 m0, s22, 34816
    s_add_u32 s24, s23, 34816
    buffer_load_dwordx4 v15, s[12:15], s24 offen sc1 lds
    s_add_u32 m0, s22, 36864
    s_add_u32 s24, s23, 36864
    buffer_load_dwordx4 v224, s[12:15], s24 offen sc1 lds
    s_add_u32 m0, s22, 38912
    s_add_u32 s24, s23, 38912
    buffer_load_dwordx4 v225, s[12:15], s24 offen sc1 lds
    s_add_u32 m0, s22, 1024
    s_add_u32 s24, s23, 1024
    buffer_load_dwordx4 v14, s[12:15], s24 offen sc1 lds
    s_add_u32 m0, s22, 3072
    s_add_u32 s24, s23, 3072
    buffer_load_dwordx4 v15, s[12:15], s24 offen sc1 lds
    s_add_u32 m0, s22, 5120
    s_add_u32 s24, s23, 5120
    buffer_load_dwordx4 v224, s[12:15], s24 offen sc1 lds
    s_add_u32 m0, s22, 7168
    s_add_u32 s24, s23, 7168
    buffer_load_dwordx4 v225, s[12:15], s24 offen sc1 lds
    s_add_u32 m0, s22, 33792
    s_add_u32 s24, s23, 33792
    buffer_load_dwordx4 v14, s[12:15], s24 offen sc1 lds
    s_add_u32 m0, s22, 35840
    s_add_u32 s24, s23, 35840
    buffer_load_dwordx4 v15, s[12:15], s24 offen sc1 lds
    s_add_u32 m0, s22, 37888
    s_add_u32 s24, s23, 37888
    buffer_load_dwordx4 v224, s[12:15], s24 offen sc1 lds
    s_add_u32 m0, s22, 39936
    s_add_u32 s24, s23, 39936
    buffer_load_dwordx4 v225, s[12:15], s24 offen sc1 lds
    s_waitcnt vmcnt(0)
    s_mov_b64 exec, 1
    ds_add_u32 v252, v253 offset:0
    s_mov_b64 exec, -1
    s_nop 1
W_1047:
    ds_read_b32 v254, v252 offset:0
    s_waitcnt lgkmcnt(0)
    v_readfirstlane_b32 s61, v254
    s_nop 3
    s_cmp_ge_u32 s61, 12
    s_cbranch_scc1 Wd_1048
    s_sub_u32 s60, s60, 1
    s_cbranch_scc0 W_1047
    s_mov_b32 s60, 0
    v_mov_b32 v254, 256
    v_mov_b32 v255, 0
    buffer_store_dword v254, v255, s[56:59], 0 offen offset:0
    s_nop 3
Wd_1048:
    ds_read_b128 v[128:131], v9 offset:0
    ds_read_b128 v[132:135], v9 offset:32768
    ds_read_b128 v[136:139], v11 offset:0
    ds_read_b128 v[140:143], v11 offset:32768
    ds_read_b128 v[144:147], v10 offset:0
    ds_read_b128 v[148:151], v10 offset:32768
    ds_read_b128 v[152:155], v12 offset:0
    ds_read_b128 v[156:159], v12 offset:32768
    s_waitcnt lgkmcnt(7)
    v_mfma_f32_16x16x32_bf16 v[160:163], v[128:131], v[64:67], 0
    ds_read_b128 v[128:131], v9 offset:256
    s_waitcnt lgkmcnt(7)
    v_mfma_f32_16x16x32_bf16 v[164:167], v[132:135], v[64:67], 0
    ds_read_b128 v[132:135], v9 offset:33024
    s_waitcnt lgkmcnt(7)
    v_mfma_f32_16x16x32_bf16 v[168:171], v[136:139], v[64:67], 0
    ds_read_b128 v[136:139], v11 offset:256
    s_waitcnt lgkmcnt(7)
    v_mfma_f32_16x16x32_bf16 v[172:175], v[140:143], v[64:67], 0
    ds_read_b128 v[140:143], v11 offset:33024
    s_waitcnt lgkmcnt(7)
    v_mfma_f32_16x16x32_bf16 v[160:163], v[144:147], v[68:71], v[160:163]
    ds_read_b128 v[144:147], v10 offset:256
    s_waitcnt lgkmcnt(7)
    v_mfma_f32_16x16x32_bf16 v[164:167], v[148:151], v[68:71], v[164:167]
    ds_read_b128 v[148:151], v10 offset:33024
    s_waitcnt lgkmcnt(7)
    v_mfma_f32_16x16x32_bf16 v[168:171], v[152:155], v[68:71], v[168:171]
    ds_read_b128 v[152:155], v12 offset:256
    s_waitcnt lgkmcnt(7)
    v_mfma_f32_16x16x32_bf16 v[172:175], v[156:159], v[68:71], v[172:175]
    ds_read_b128 v[156:159], v12 offset:33024
    s_waitcnt lgkmcnt(7)
    v_mfma_f32_16x16x32_bf16 v[160:163], v[128:131], v[72:75], v[160:163]
    ds_read_b128 v[128:131], v9 offset:512
    s_waitcnt lgkmcnt(7)
    v_mfma_f32_16x16x32_bf16 v[164:167], v[132:135], v[72:75], v[164:167]
    ds_read_b128 v[132:135], v9 offset:33280
    s_waitcnt lgkmcnt(7)
    v_mfma_f32_16x16x32_bf16 v[168:171], v[136:139], v[72:75], v[168:171]
    ds_read_b128 v[136:139], v11 offset:512
    s_waitcnt lgkmcnt(7)
    v_mfma_f32_16x16x32_bf16 v[172:175], v[140:143], v[72:75], v[172:175]
    ds_read_b128 v[140:143], v11 offset:33280
    s_waitcnt lgkmcnt(7)
    v_mfma_f32_16x16x32_bf16 v[160:163], v[144:147], v[76:79], v[160:163]
    ds_read_b128 v[144:147], v10 offset:512
    s_waitcnt lgkmcnt(7)
    v_mfma_f32_16x16x32_bf16 v[164:167], v[148:151], v[76:79], v[164:167]
    ds_read_b128 v[148:151], v10 offset:33280
    s_waitcnt lgkmcnt(7)
    v_mfma_f32_16x16x32_bf16 v[168:171], v[152:155], v[76:79], v[168:171]
    ds_read_b128 v[152:155], v12 offset:512
    s_waitcnt lgkmcnt(7)
    v_mfma_f32_16x16x32_bf16 v[172:175], v[156:159], v[76:79], v[172:175]
    ds_read_b128 v[156:159], v12 offset:33280
    s_waitcnt lgkmcnt(7)
    v_mfma_f32_16x16x32_bf16 v[160:163], v[128:131], v[80:83], v[160:163]
    ds_read_b128 v[128:131], v9 offset:768
    s_waitcnt lgkmcnt(7)
    v_mfma_f32_16x16x32_bf16 v[164:167], v[132:135], v[80:83], v[164:167]
    ds_read_b128 v[132:135], v9 offset:33536
    s_waitcnt lgkmcnt(7)
    v_mfma_f32_16x16x32_bf16 v[168:171], v[136:139], v[80:83], v[168:171]
    ds_read_b128 v[136:139], v11 offset:768
    s_waitcnt lgkmcnt(7)
    v_mfma_f32_16x16x32_bf16 v[172:175], v[140:143], v[80:83], v[172:175]
    ds_read_b128 v[140:143], v11 offset:33536
    s_waitcnt lgkmcnt(7)
    v_mfma_f32_16x16x32_bf16 v[160:163], v[144:147], v[84:87], v[160:163]
    ds_read_b128 v[144:147], v10 offset:768
    s_waitcnt lgkmcnt(7)
    v_mfma_f32_16x16x32_bf16 v[164:167], v[148:151], v[84:87], v[164:167]
    ds_read_b128 v[148:151], v10 offset:33536
    s_waitcnt lgkmcnt(7)
    v_mfma_f32_16x16x32_bf16 v[168:171], v[152:155], v[84:87], v[168:171]
    ds_read_b128 v[152:155], v12 offset:768
    s_waitcnt lgkmcnt(7)
    v_mfma_f32_16x16x32_bf16 v[172:175], v[156:159], v[84:87], v[172:175]
    ds_read_b128 v[156:159], v12 offset:33536
    s_waitcnt lgkmcnt(7)
    v_mfma_f32_16x16x32_bf16 v[160:163], v[128:131], v[88:91], v[160:163]
    ds_read_b128 v[128:131], v9 offset:1024
    s_waitcnt lgkmcnt(7)
    v_mfma_f32_16x16x32_bf16 v[164:167], v[132:135], v[88:91], v[164:167]
    ds_read_b128 v[132:135], v9 offset:33792
    s_waitcnt lgkmcnt(7)
    v_mfma_f32_16x16x32_bf16 v[168:171], v[136:139], v[88:91], v[168:171]
    ds_read_b128 v[136:139], v11 offset:1024
    s_waitcnt lgkmcnt(7)
    v_mfma_f32_16x16x32_bf16 v[172:175], v[140:143], v[88:91], v[172:175]
    ds_read_b128 v[140:143], v11 offset:33792
    s_waitcnt lgkmcnt(7)
    v_mfma_f32_16x16x32_bf16 v[160:163], v[144:147], v[92:95], v[160:163]
    ds_read_b128 v[144:147], v10 offset:1024
    s_waitcnt lgkmcnt(7)
    v_mfma_f32_16x16x32_bf16 v[164:167], v[148:151], v[92:95], v[164:167]
    ds_read_b128 v[148:151], v10 offset:33792
    s_waitcnt lgkmcnt(7)
    v_mfma_f32_16x16x32_bf16 v[168:171], v[152:155], v[92:95], v[168:171]
    ds_read_b128 v[152:155], v12 offset:1024
    s_waitcnt lgkmcnt(7)
    v_mfma_f32_16x16x32_bf16 v[172:175], v[156:159], v[92:95], v[172:175]
    ds_read_b128 v[156:159], v12 offset:33792
    s_waitcnt lgkmcnt(7)
    v_mfma_f32_16x16x32_bf16 v[160:163], v[128:131], v[96:99], v[160:163]
    ds_read_b128 v[128:131], v9 offset:1280
    s_waitcnt lgkmcnt(7)
    v_mfma_f32_16x16x32_bf16 v[164:167], v[132:135], v[96:99], v[164:167]
    ds_read_b128 v[132:135], v9 offset:34048
    s_waitcnt lgkmcnt(7)
    v_mfma_f32_16x16x32_bf16 v[168:171], v[136:139], v[96:99], v[168:171]
    ds_read_b128 v[136:139], v11 offset:1280
    s_waitcnt lgkmcnt(7)
    v_mfma_f32_16x16x32_bf16 v[172:175], v[140:143], v[96:99], v[172:175]
    ds_read_b128 v[140:143], v11 offset:34048
    s_waitcnt lgkmcnt(7)
    v_mfma_f32_16x16x32_bf16 v[160:163], v[144:147], v[100:103], v[160:163]
    ds_read_b128 v[144:147], v10 offset:1280
    s_waitcnt lgkmcnt(7)
    v_mfma_f32_16x16x32_bf16 v[164:167], v[148:151], v[100:103], v[164:167]
    ds_read_b128 v[148:151], v10 offset:34048
    s_waitcnt lgkmcnt(7)
    v_mfma_f32_16x16x32_bf16 v[168:171], v[152:155], v[100:103], v[168:171]
    ds_read_b128 v[152:155], v12 offset:1280
    s_waitcnt lgkmcnt(7)
    v_mfma_f32_16x16x32_bf16 v[172:175], v[156:159], v[100:103], v[172:175]
    ds_read_b128 v[156:159], v12 offset:34048
    s_waitcnt lgkmcnt(7)
    v_mfma_f32_16x16x32_bf16 v[160:163], v[128:131], v[104:107], v[160:163]
    ds_read_b128 v[128:131], v9 offset:1536
    s_waitcnt lgkmcnt(7)
    v_mfma_f32_16x16x32_bf16 v[164:167], v[132:135], v[104:107], v[164:167]
    ds_read_b128 v[132:135], v9 offset:34304
    s_waitcnt lgkmcnt(7)
    v_mfma_f32_16x16x32_bf16 v[168:171], v[136:139], v[104:107], v[168:171]
    ds_read_b128 v[136:139], v11 offset:1536
    s_waitcnt lgkmcnt(7)
    v_mfma_f32_16x16x32_bf16 v[172:175], v[140:143], v[104:107], v[172:175]
    ds_read_b128 v[140:143], v11 offset:34304
    s_waitcnt lgkmcnt(7)
    v_mfma_f32_16x16x32_bf16 v[160:163], v[144:147], v[108:111], v[160:163]
    ds_read_b128 v[144:147], v10 offset:1536
    s_waitcnt lgkmcnt(7)
    v_mfma_f32_16x16x32_bf16 v[164:167], v[148:151], v[108:111], v[164:167]
    ds_read_b128 v[148:151], v10 offset:34304
    s_waitcnt lgkmcnt(7)
    v_mfma_f32_16x16x32_bf16 v[168:171], v[152:155], v[108:111], v[168:171]
    ds_read_b128 v[152:155], v12 offset:1536
    s_waitcnt lgkmcnt(7)
    v_mfma_f32_16x16x32_bf16 v[172:175], v[156:159], v[108:111], v[172:175]
    ds_read_b128 v[156:159], v12 offset:34304
    s_waitcnt lgkmcnt(7)
    v_mfma_f32_16x16x32_bf16 v[160:163], v[128:131], v[112:115], v[160:163]
    ds_read_b128 v[128:131], v9 offset:1792
    s_waitcnt lgkmcnt(7)
    v_mfma_f32_16x16x32_bf16 v[164:167], v[132:135], v[112:115], v[164:167]
    ds_read_b128 v[132:135], v9 offset:34560
    s_waitcnt lgkmcnt(7)
    v_mfma_f32_16x16x32_bf16 v[168:171], v[136:139], v[112:115], v[168:171]
    ds_read_b128 v[136:139], v11 offset:1792
    s_waitcnt lgkmcnt(7)
    v_mfma_f32_16x16x32_bf16 v[172:175], v[140:143], v[112:115], v[172:175]
    ds_read_b128 v[140:143], v11 offset:34560
    s_waitcnt lgkmcnt(7)
    v_mfma_f32_16x16x32_bf16 v[160:163], v[144:147], v[116:119], v[160:163]
    ds_read_b128 v[144:147], v10 offset:1792
    s_waitcnt lgkmcnt(7)
    v_mfma_f32_16x16x32_bf16 v[164:167], v[148:151], v[116:119], v[164:167]
    ds_read_b128 v[148:151], v10 offset:34560
    s_waitcnt lgkmcnt(7)
    v_mfma_f32_16x16x32_bf16 v[168:171], v[152:155], v[116:119], v[168:171]
    ds_read_b128 v[152:155], v12 offset:1792
    s_waitcnt lgkmcnt(7)
    v_mfma_f32_16x16x32_bf16 v[172:175], v[156:159], v[116:119], v[172:175]
    ds_read_b128 v[156:159], v12 offset:34560
    s_waitcnt lgkmcnt(7)
    v_mfma_f32_16x16x32_bf16 v[160:163], v[128:131], v[120:123], v[160:163]
    s_waitcnt lgkmcnt(6)
    v_mfma_f32_16x16x32_bf16 v[164:167], v[132:135], v[120:123], v[164:167]
    s_waitcnt lgkmcnt(5)
    v_mfma_f32_16x16x32_bf16 v[168:171], v[136:139], v[120:123], v[168:171]
    s_waitcnt lgkmcnt(4)
    v_mfma_f32_16x16x32_bf16 v[172:175], v[140:143], v[120:123], v[172:175]
    s_waitcnt lgkmcnt(3)
    v_mfma_f32_16x16x32_bf16 v[160:163], v[144:147], v[124:127], v[160:163]
    s_waitcnt lgkmcnt(2)
    v_mfma_f32_16x16x32_bf16 v[164:167], v[148:151], v[124:127], v[164:167]
    s_waitcnt lgkmcnt(1)
    v_mfma_f32_16x16x32_bf16 v[168:171], v[152:155], v[124:127], v[168:171]
    s_waitcnt lgkmcnt(0)
    v_mfma_f32_16x16x32_bf16 v[172:175], v[156:159], v[124:127], v[172:175]
    s_nop 1
    v_cvt_pk_bf16_f32 v128, v160, v161
    v_cvt_pk_bf16_f32 v129, v162, v163
    v_cvt_pk_bf16_f32 v130, v164, v165
    v_cvt_pk_bf16_f32 v131, v166, v167
    v_cvt_pk_bf16_f32 v132, v168, v169
    v_cvt_pk_bf16_f32 v133, v170, v171
    v_cvt_pk_bf16_f32 v134, v172, v173
    v_cvt_pk_bf16_f32 v135, v174, v175
    v_mfma_f32_16x16x32_bf16 v[144:147], v[128:131], v[16:19], 0
    v_mfma_f32_16x16x32_bf16 v[148:151], v[128:131], v[24:27], 0
    v_mfma_f32_16x16x32_bf16 v[152:155], v[128:131], v[32:35], 0
    v_mfma_f32_16x16x32_bf16 v[156:159], v[128:131], v[40:43], 0
    v_mfma_f32_16x16x32_bf16 v[144:147], v[132:135], v[20:23], v[144:147]
    v_mfma_f32_16x16x32_bf16 v[148:151], v[132:135], v[28:31], v[148:151]
    v_mfma_f32_16x16x32_bf16 v[152:155], v[132:135], v[36:39], v[152:155]
    v_mfma_f32_16x16x32_bf16 v[156:159], v[132:135], v[44:47], v[156:159]
    s_lshl_b32 s22, s3, 12
    s_add_u32 s22, s22, 65536
    v_lshlrev_b32 v3, 4, v0
    v_add_u32 v3, s22, v3
    s_lshl_b32 s22, s20, 10
    s_lshl_b32 s23, s21, 7
    s_add_u32 s22, s22, s23
    s_lshl_b32 s23, s3, 5
    s_add_u32 s22, s22, s23
    v_pk_fma_f32 v[144:145], v[144:145], v[200:201], v[176:177]
    v_pk_fma_f32 v[146:147], v[146:147], v[200:201], v[178:179]
    v_pk_fma_f32 v[148:149], v[148:149], v[202:203], v[180:181]
    v_pk_fma_f32 v[150:151], v[150:151], v[202:203], v[182:183]
    v_pk_fma_f32 v[152:153], v[152:153], v[204:205], v[184:185]
    v_pk_fma_f32 v[154:155], v[154:155], v[204:205], v[186:187]
    v_pk_fma_f32 v[156:157], v[156:157], v[206:207], v[188:189]
    v_pk_fma_f32 v[158:159], v[158:159], v[206:207], v[190:191]
    s_nop 4
W_1049:
    ds_read_b32 v254, v252 offset:36
    s_waitcnt lgkmcnt(0)
    v_readfirstlane_b32 s61, v254
    s_nop 3
    s_cmp_ge_u32 s61, 4
    s_cbranch_scc1 Wd_1050
    s_sub_u32 s60, s60, 1
    s_cbranch_scc0 W_1049
    s_mov_b32 s60, 0
    v_mov_b32 v254, 262
    v_mov_b32 v255, 0
    buffer_store_dword v254, v255, s[56:59], 0 offen offset:24
    s_nop 3
Wd_1050:
    ds_read_b128 v[64:67], v3 offset:0
    ds_read_b128 v[68:71], v3 offset:1024
    ds_read_b128 v[80:83], v3 offset:16384
    ds_read_b128 v[84:87], v3 offset:17408
    ds_read_b128 v[96:99], v3 offset:32768
    ds_read_b128 v[100:103], v3 offset:33792
    ds_read_b128 v[112:115], v3 offset:49152
    ds_read_b128 v[116:119], v3 offset:50176
    ds_read_b32 v254, v252 offset:96
    s_waitcnt lgkmcnt(0)
    v_readfirstlane_b32 s61, v254
    s_nop 3
    s_cmp_ge_u32 s61, 4
    s_nop 1
    s_cbranch_scc0 TS_1051
    ds_read_b128 v[72:75], v3 offset:2048
    ds_read_b128 v[76:79], v3 offset:3072
    ds_read_b128 v[88:91], v3 offset:18432
    ds_read_b128 v[92:95], v3 offset:19456
    ds_read_b128 v[104:107], v3 offset:34816
    ds_read_b128 v[108:111], v3 offset:35840
    ds_read_b128 v[120:123], v3 offset:51200
    ds_read_b128 v[124:127], v3 offset:52224
    v_pk_add_f32 v[64:65], v[64:65], v[80:81]
    v_pk_add_f32 v[66:67], v[66:67], v[82:83]
    v_pk_add_f32 v[68:69], v[68:69], v[84:85]
    v_pk_add_f32 v[70:71], v[70:71], v[86:87]
    v_pk_add_f32 v[96:97], v[96:97], v[112:113]
    v_pk_add_f32 v[98:99], v[98:99], v[114:115]
    v_pk_add_f32 v[100:101], v[100:101], v[116:117]
    v_pk_add_f32 v[102:103], v[102:103], v[118:119]
    v_pk_add_f32 v[64:65], v[64:65], v[96:97]
    v_pk_add_f32 v[66:67], v[66:67], v[98:99]
    v_pk_add_f32 v[68:69], v[68:69], v[100:101]
    v_pk_add_f32 v[70:71], v[70:71], v[102:103]
    v_pk_fma_f32 v[144:145], v[64:65], v[192:193], v[144:145]
    v_pk_fma_f32 v[146:147], v[66:67], v[192:193], v[146:147]
    v_pk_fma_f32 v[148:149], v[68:69], v[194:195], v[148:149]
    v_pk_fma_f32 v[150:151], v[70:71], v[194:195], v[150:151]
    v_cvt_pk_bf16_f32 v128, v144, v145
    v_cvt_pk_bf16_f32 v129, v146, v147
    v_cvt_pk_bf16_f32 v130, v148, v149
    v_cvt_pk_bf16_f32 v131, v150, v151
    s_nop 0
    v_permlane16_swap_b32 v128, v130
    v_permlane16_swap_b32 v129, v131
    buffer_store_dwordx4 v[128:131], v13, s[48:51], s22 offen
    s_nop 3
    s_branch TJ_1052
TS_1051:
    v_pk_add_f32 v[64:65], v[64:65], v[80:81]
    v_pk_add_f32 v[66:67], v[66:67], v[82:83]
    v_pk_add_f32 v[68:69], v[68:69], v[84:85]
    v_pk_add_f32 v[70:71], v[70:71], v[86:87]
    v_pk_add_f32 v[96:97], v[96:97], v[112:113]
    v_pk_add_f32 v[98:99], v[98:99], v[114:115]
    v_pk_add_f32 v[100:101], v[100:101], v[116:117]
    v_pk_add_f32 v[102:103], v[102:103], v[118:119]
    v_pk_add_f32 v[64:65], v[64:65], v[96:97]
    v_pk_add_f32 v[66:67], v[66:67], v[98:99]
    v_pk_add_f32 v[68:69], v[68:69], v[100:101]
    v_pk_add_f32 v[70:71], v[70:71], v[102:103]
    v_pk_fma_f32 v[144:145], v[64:65], v[192:193], v[144:145]
    v_pk_fma_f32 v[146:147], v[66:67], v[192:193], v[146:147]
    v_pk_fma_f32 v[148:149], v[68:69], v[194:195], v[148:149]
    v_pk_fma_f32 v[150:151], v[70:71], v[194:195], v[150:151]
    v_cvt_pk_bf16_f32 v128, v144, v145
    v_cvt_pk_bf16_f32 v129, v146, v147
    v_cvt_pk_bf16_f32 v130, v148, v149
    v_cvt_pk_bf16_f32 v131, v150, v151
    s_nop 0
    v_permlane16_swap_b32 v128, v130
    v_permlane16_swap_b32 v129, v131
    buffer_store_dwordx4 v[128:131], v13, s[48:51], s22 offen
    s_nop 3
W_1053:
    ds_read_b32 v254, v252 offset:96
    s_waitcnt lgkmcnt(0)
    v_readfirstlane_b32 s61, v254
    s_nop 3
    s_cmp_ge_u32 s61, 4
    s_cbranch_scc1 Wd_1054
    s_sub_u32 s60, s60, 1
    s_cbranch_scc0 W_1053
    s_mov_b32 s60, 0
    v_mov_b32 v254, 264
    v_mov_b32 v255, 0
    buffer_store_dword v254, v255, s[56:59], 0 offen offset:32
    s_nop 3
Wd_1054:
    ds_read_b128 v[72:75], v3 offset:2048
    ds_read_b128 v[76:79], v3 offset:3072
    ds_read_b128 v[88:91], v3 offset:18432
    ds_read_b128 v[92:95], v3 offset:19456
    ds_read_b128 v[104:107], v3 offset:34816
    ds_read_b128 v[108:111], v3 offset:35840
    ds_read_b128 v[120:123], v3 offset:51200
    ds_read_b128 v[124:127], v3 offset:52224
    s_nop 1
TJ_1052:
    s_waitcnt lgkmcnt(0)
    v_pk_add_f32 v[72:73], v[72:73], v[88:89]
    v_pk_add_f32 v[74:75], v[74:75], v[90:91]
    v_pk_add_f32 v[76:77], v[76:77], v[92:93]
    v_pk_add_f32 v[78:79], v[78:79], v[94:95]
    v_pk_add_f32 v[104:105], v[104:105], v[120:121]
    v_pk_add_f32 v[106:107], v[106:107], v[122:123]
    v_pk_add_f32 v[108:109], v[108:109], v[124:125]
    v_pk_add_f32 v[110:111], v[110:111], v[126:127]
    v_pk_add_f32 v[72:73], v[72:73], v[104:105]
    v_pk_add_f32 v[74:75], v[74:75], v[106:107]
    v_pk_add_f32 v[76:77], v[76:77], v[108:109]
    v_pk_add_f32 v[78:79], v[78:79], v[110:111]
    v_pk_fma_f32 v[152:153], v[72:73], v[196:197], v[152:153]
    v_pk_fma_f32 v[154:155], v[74:75], v[196:197], v[154:155]
    v_pk_fma_f32 v[156:157], v[76:77], v[198:199], v[156:157]
    v_pk_fma_f32 v[158:159], v[78:79], v[198:199], v[158:159]
    v_cvt_pk_bf16_f32 v132, v152, v153
    v_cvt_pk_bf16_f32 v133, v154, v155
    v_cvt_pk_bf16_f32 v134, v156, v157
    v_cvt_pk_bf16_f32 v135, v158, v159
    s_nop 0
    v_permlane16_swap_b32 v132, v134
    v_permlane16_swap_b32 v133, v135
    s_add_u32 s22, s22, 1048576
    buffer_store_dwordx4 v[132:135], v13, s[48:51], s22 offen
    s_nop 2
    s_branch L_fin
L_B:
    s_load_dwordx2 s[4:5], s[0:1], 0
    s_load_dwordx2 s[8:9], s[0:1], 32
    s_load_dwordx2 s[12:13], s[0:1], 88
    s_load_dwordx2 s[16:17], s[0:1], 40
    s_load_dwordx2 s[40:41], s[0:1], 48
    s_load_dwordx2 s[56:57], s[0:1], 80
    s_and_b32 s24, s2, 7
    s_lshr_b32 s25, s2, 3
    s_lshr_b32 s20, s24, 1
    s_lshl_b32 s20, s20, 3
    s_and_b32 s21, s25, 7
    s_add_u32 s20, s20, s21
    s_and_b32 s21, s24, 1
    s_lshl_b32 s21, s21, 2
    s_lshr_b32 s25, s25, 3
    s_add_u32 s21, s21, s25
    v_lshrrev_b32 v15, 4, v0
    v_and_b32 v16, 15, v0
    v_lshrrev_b32 v9, 3, v0
    v_lshrrev_b32 v10, 4, v0
    v_xor_b32 v10, v10, v0
    v_and_b32 v10, 7, v10
    v_lshlrev_b32 v10, 4, v10
    v_mul_u32_u24 v9, 32768, v9
    v_add_u32 v7, v9, v10
    v_xor_b32 v8, 64, v7
    s_mul_i32 s38, s3, 524288
    s_lshl_b32 s24, s20, 10
    s_add_u32 s38, s38, s24
    s_lshl_b32 s39, s3, 11
    s_mul_i32 s22, s21, 11
    s_max_u32 s26, s21, 6
    s_sub_u32 s26, s26, 6
    s_sub_u32 s22, s22, s26
    s_cmp_lt_u32 s21, 6
    s_cselect_b32 s23, 11, 10
    s_mul_i32 s26, s3, 3
    s_add_u32 s22, s22, s26
    s_sub_u32 s23, s23, s26
    s_min_u32 s23, s23, 3
    s_mov_b32 s50, s21
    v_add_u32 v9, 0, v0
    v_mul_u32_u24 v14, 43691, v9
    v_lshrrev_b32 v14, 18, v14
    v_mul_u32_u24 v1, 6, v14
    v_sub_u32 v9, v9, v1
    v_and_b32 v1, 0x13, v14
    v_and_b32 v4, 4, v14
    v_lshl_or_b32 v1, v4, 1, v1
    v_and_b32 v4, 8, v14
    v_lshrrev_b32 v4, 1, v4
    v_or_b32 v1, v1, v4
    v_mul_u32_u24 v1, 2752, v1
    v_lshl_add_u32 v1, v9, 4, v1
    v_lshrrev_b32 v9, 1, v9
    v_cmp_le_u32 vcc, s23, v9
    v_mov_b32 v14, 0x7ff00000
    s_nop 0
    v_cndmask_b32 v1, v1, v14, vcc
    v_add_u32 v9, 64, v0
    v_mul_u32_u24 v14, 43691, v9
    v_lshrrev_b32 v14, 18, v14
    v_mul_u32_u24 v2, 6, v14
    v_sub_u32 v9, v9, v2
    v_and_b32 v2, 0x13, v14
    v_and_b32 v4, 4, v14
    v_lshl_or_b32 v2, v4, 1, v2
    v_and_b32 v4, 8, v14
    v_lshrrev_b32 v4, 1, v4
    v_or_b32 v2, v2, v4
    v_mul_u32_u24 v2, 2752, v2
    v_lshl_add_u32 v2, v9, 4, v2
    v_lshrrev_b32 v9, 1, v9
    v_cmp_le_u32 vcc, s23, v9
    v_mov_b32 v14, 0x7ff00000
    s_nop 0
    v_cndmask_b32 v2, v2, v14, vcc
    v_add_u32 v9, 128, v0
    v_mul_u32_u24 v14, 43691, v9
    v_lshrrev_b32 v14, 18, v14
    v_mul_u32_u24 v3, 6, v14
    v_sub_u32 v9, v9, v3
    v_and_b32 v3, 0x13, v14
    v_and_b32 v4, 4, v14
    v_lshl_or_b32 v3, v4, 1, v3
    v_and_b32 v4, 8, v14
    v_lshrrev_b32 v4, 1, v4
    v_or_b32 v3, v3, v4
    v_mul_u32_u24 v3, 2752, v3
    v_lshl_add_u32 v3, v9, 4, v3
    v_lshrrev_b32 v9, 1, v9
    v_cmp_le_u32 vcc, s23, v9
    v_mov_b32 v14, 0x7ff00000
    s_nop 0
    v_cndmask_b32 v3, v3, v14, vcc
    s_mul_i32 s27, s3, 16384
    s_add_u32 s27, s27, 65536
    s_lshl_b32 s28, s22, 5
    s_lshl_b32 s36, s50, 1
    v_mov_b32 v252, 162816
    v_mov_b32 v253, 1
    s_mov_b32 s60, 100000
    s_waitcnt lgkmcnt(0)
    s_and_b32 s5, s5, 0xffff
    s_mov_b32 s6, 2097152
    s_mov_b32 s7, 0x20000
    s_add_u32 s62, s50, 1
    s_and_b32 s62, s62, 7
    s_lshl_b32 s62, s62, 7
    s_add_u32 s62, s62, s38
    s_add_u32 m0, s39, 8192
    s_nop 0
    buffer_load_dwordx4 v7, s[4:7], s62 offen lds
    s_add_u32 s62, s62, 262144
    s_add_u32 m0, s39, 9216
    s_nop 0
    buffer_load_dwordx4 v8, s[4:7], s62 offen lds
    s_and_b32 s9, s9, 0xffff
    s_mov_b32 s10, 1409024
    s_mov_b32 s11, 0x20000
    s_and_b32 s17, s17, 0xffff
    s_mov_b32 s18, 2752
    s_mov_b32 s19, 0x20000
    s_and_b32 s41, s41, 0xffff
    s_mov_b32 s42, 1409024
    s_mov_b32 s43, 0x20000
    s_and_b32 s57, s57, 0xffff
    s_mov_b32 s58, 256
    s_mov_b32 s59, 0x20000
    s_and_b32 s13, s13, 0xffff
    s_mov_b32 s14, 16777216
    s_mov_b32 s15, 0x20000
    s_barrier
    s_mov_b32 s63, 15777792
    v_mov_b32 v254, 0
    buffer_load_dword v251, v254, s[12:15], s63 offen sc1
    v_lshlrev_b32 v9, 3, v15
    s_lshl_b32 s24, s22, 5
    buffer_load_dwordx2 v[48:49], v9, s[16:19], s24 offen offset:0
    buffer_load_dwordx2 v[50:51], v9, s[16:19], s24 offen offset:32
    buffer_load_dwordx2 v[52:53], v9, s[16:19], s24 offen offset:64
    s_add_u32 s26, s36, 0
    s_and_b32 s26, s26, 15
    s_mul_i32 s26, s26, 88064
    s_add_u32 s26, s26, s28
    s_add_u32 m0, s27, 0
    s_nop 0
    buffer_load_dwordx4 v1, s[8:11], s26 offen lds
    s_add_u32 m0, s27, 1024
    s_nop 0
    buffer_load_dwordx4 v2, s[8:11], s26 offen lds
    s_add_u32 m0, s27, 2048
    s_nop 0
    buffer_load_dwordx4 v3, s[8:11], s26 offen lds
    s_add_u32 s26, s36, 1
    s_and_b32 s26, s26, 15
    s_mul_i32 s26, s26, 88064
    s_add_u32 s26, s26, s28
    s_add_u32 m0, s27, 3072
    s_nop 0
    buffer_load_dwordx4 v1, s[8:11], s26 offen lds
    s_add_u32 m0, s27, 4096
    s_nop 0
    buffer_load_dwordx4 v2, s[8:11], s26 offen lds
    s_add_u32 m0, s27, 5120
    s_nop 0
    buffer_load_dwordx4 v3, s[8:11], s26 offen lds
    s_add_u32 s62, s50, 2
    s_and_b32 s62, s62, 7
    s_lshl_b32 s62, s62, 7
    s_add_u32 s62, s62, s38
    s_add_u32 m0, s39, 16384
    s_nop 0
    buffer_load_dwordx4 v7, s[4:7], s62 offen lds
    s_add_u32 s62, s62, 262144
    s_add_u32 m0, s39, 17408
    s_nop 0
    buffer_load_dwordx4 v8, s[4:7], s62 offen lds
    s_add_u32 s26, s36, 2
    s_and_b32 s26, s26, 15
    s_mul_i32 s26, s26, 88064
    s_add_u32 s26, s26, s28
    s_add_u32 m0, s27, 6144
    s_nop 0
    buffer_load_dwordx4 v1, s[8:11], s26 offen lds
    s_add_u32 m0, s27, 7168
    s_nop 0
    buffer_load_dwordx4 v2, s[8:11], s26 offen lds
    s_add_u32 m0, s27, 8192
    s_nop 0
    buffer_load_dwordx4 v3, s[8:11], s26 offen lds
    s_add_u32 s26, s36, 3
    s_and_b32 s26, s26, 15
    s_mul_i32 s26, s26, 88064
    s_add_u32 s26, s26, s28
    s_add_u32 m0, s27, 9216
    s_nop 0
    buffer_load_dwordx4 v1, s[8:11], s26 offen lds
    s_add_u32 m0, s27, 10240
    s_nop 0
    buffer_load_dwordx4 v2, s[8:11], s26 offen lds
    s_add_u32 m0, s27, 11264
    s_nop 0
    buffer_load_dwordx4 v3, s[8:11], s26 offen lds
    v_lshrrev_b32 v9, 2, v16
    v_and_b32 v14, 1, v15
    v_lshl_add_u32 v9, v14, 2, v9
    v_lshrrev_b32 v14, 1, v15
    v_lshl_add_u32 v9, v14, 4, v9
    v_mul_u32_u24 v9, 96, v9
    v_and_b32 v14, 3, v16
    v_lshl_add_u32 v9, v14, 3, v9
    v_add_u32 v4, s27, v9
    v_lshrrev_b32 v9, 1, v16
    v_xor_b32 v9, v9, v15
    v_lshlrev_b32 v9, 4, v9
    v_lshl_add_u32 v5, v16, 7, v9
    v_xor_b32 v6, 64, v5
    s_waitcnt vmcnt(14)
    v_lshlrev_b32 v20, 16, v48
    v_and_b32 v21, 0xffff0000, v48
    v_lshlrev_b32 v22, 16, v49
    v_and_b32 v23, 0xffff0000, v49
    v_lshlrev_b32 v24, 16, v50
    v_and_b32 v25, 0xffff0000, v50
    v_lshlrev_b32 v26, 16, v51
    v_and_b32 v27, 0xffff0000, v51
    v_lshlrev_b32 v28, 16, v52
    v_and_b32 v29, 0xffff0000, v52
    v_lshlrev_b32 v30, 16, v53
    v_and_b32 v31, 0xffff0000, v53
    s_lshr_b32 s55, s2, 3
    s_lshl_b32 s55, s55, 2
    s_add_u32 s55, s55, s3
    s_lshr_b32 s54, s55, 5
    s_mul_i32 s54, s54, 360448
    s_and_b32 s55, s55, 31
    s_mul_i32 s55, s55, 4096
    s_add_u32 s55, s55, s54
    v_lshlrev_b32 v248, 7, v0
    v_mov_b32 v250, 0x7ff00000
    v_cmp_gt_u32 vcc, 8, v0
    s_nop 1
    v_cndmask_b32 v248, v250, v248, vcc
    s_waitcnt vmcnt(11)
    s_mov_b64 exec, 1
    ds_add_u32 v252, v253 offset:68
    s_mov_b64 exec, -1
    s_nop 1
W_1055:
    ds_read_b32 v254, v252 offset:64
    s_waitcnt lgkmcnt(0)
    v_readfirstlane_b32 s61, v254
    s_nop 3
    s_cmp_ge_u32 s61, 4
    s_cbranch_scc1 Wd_1056
    s_sub_u32 s60, s60, 1
    s_cbranch_scc0 W_1055
    s_mov_b32 s60, 0
    v_mov_b32 v254, 270
    v_mov_b32 v255, 0
    buffer_store_dword v254, v255, s[56:59], 0 offen offset:56
    s_nop 3
Wd_1056:
    ds_read_b64_tr_b16 v[64:65], v4 offset:0
    ds_read_b64_tr_b16 v[66:67], v4 offset:768
    ds_read_b64_tr_b16 v[68:69], v4 offset:32
    ds_read_b64_tr_b16 v[70:71], v4 offset:800
    ds_read_b64_tr_b16 v[72:73], v4 offset:64
    ds_read_b64_tr_b16 v[74:75], v4 offset:832
    ds_read_b128 v[32:35], v5 offset:0
    ds_read_b128 v[36:39], v5 offset:2048
    ds_read_b128 v[40:43], v5 offset:4096
    ds_read_b128 v[44:47], v5 offset:6144
    s_waitcnt lgkmcnt(0)
    v_mfma_f32_16x16x32_bf16 v[88:91], v[64:67], v[32:35], v[20:23]
    s_add_u32 s62, s50, 3
    s_and_b32 s62, s62, 7
    s_lshl_b32 s62, s62, 7
    s_add_u32 s62, s62, s38
    s_add_u32 m0, s39, 24576
    s_nop 0
    buffer_load_dwordx4 v7, s[4:7], s62 offen lds
    s_add_u32 s62, s62, 262144
    s_add_u32 m0, s39, 25600
    s_nop 0
    buffer_load_dwordx4 v8, s[4:7], s62 offen lds
    s_add_u32 s26, s36, 4
    s_and_b32 s26, s26, 15
    s_mul_i32 s26, s26, 88064
    s_add_u32 s26, s26, s28
    s_add_u32 m0, s27, 0
    s_nop 0
    buffer_load_dwordx4 v1, s[8:11], s26 offen lds
    v_mfma_f32_16x16x32_bf16 v[104:107], v[68:71], v[32:35], v[24:27]
    s_add_u32 m0, s27, 1024
    s_nop 0
    buffer_load_dwordx4 v2, s[8:11], s26 offen lds
    s_add_u32 m0, s27, 2048
    s_nop 0
    buffer_load_dwordx4 v3, s[8:11], s26 offen lds
    v_mfma_f32_16x16x32_bf16 v[120:123], v[72:75], v[32:35], v[28:31]
    s_waitcnt vmcnt(13)
    ds_read_b64_tr_b16 v[76:77], v4 offset:3072
    v_mfma_f32_16x16x32_bf16 v[92:95], v[64:67], v[36:39], v[20:23]
    ds_read_b64_tr_b16 v[78:79], v4 offset:3840
    ds_read_b64_tr_b16 v[80:81], v4 offset:3104
    v_mfma_f32_16x16x32_bf16 v[108:111], v[68:71], v[36:39], v[24:27]
    ds_read_b64_tr_b16 v[82:83], v4 offset:3872
    ds_read_b64_tr_b16 v[84:85], v4 offset:3136
    v_mfma_f32_16x16x32_bf16 v[124:127], v[72:75], v[36:39], v[28:31]
    ds_read_b64_tr_b16 v[86:87], v4 offset:3904
    ds_read_b128 v[48:51], v6 offset:0
    v_mfma_f32_16x16x32_bf16 v[96:99], v[64:67], v[40:43], v[20:23]
    ds_read_b128 v[52:55], v6 offset:2048
    ds_read_b128 v[56:59], v6 offset:4096
    v_mfma_f32_16x16x32_bf16 v[112:115], v[68:71], v[40:43], v[24:27]
    ds_read_b128 v[60:63], v6 offset:6144
    ds_read_b32 v17, v252 offset:68
    v_mfma_f32_16x16x32_bf16 v[128:131], v[72:75], v[40:43], v[28:31]
    v_mfma_f32_16x16x32_bf16 v[100:103], v[64:67], v[44:47], v[20:23]
    v_mfma_f32_16x16x32_bf16 v[116:119], v[68:71], v[44:47], v[24:27]
    v_mfma_f32_16x16x32_bf16 v[132:135], v[72:75], v[44:47], v[28:31]
    s_waitcnt lgkmcnt(0)
    v_mfma_f32_16x16x32_bf16 v[88:91], v[76:79], v[48:51], v[88:91]
    s_add_u32 s26, s36, 5
    s_and_b32 s26, s26, 15
    s_mul_i32 s26, s26, 88064
    s_add_u32 s26, s26, s28
    s_add_u32 m0, s27, 3072
    s_nop 0
    buffer_load_dwordx4 v1, s[8:11], s26 offen lds
    s_add_u32 m0, s27, 4096
    s_nop 0
    buffer_load_dwordx4 v2, s[8:11], s26 offen lds
    v_mfma_f32_16x16x32_bf16 v[104:107], v[80:83], v[48:51], v[104:107]
    s_add_u32 m0, s27, 5120
    s_nop 0
    buffer_load_dwordx4 v3, s[8:11], s26 offen lds
    s_waitcnt vmcnt(11)
    v_mfma_f32_16x16x32_bf16 v[120:123], v[84:87], v[48:51], v[120:123]
    s_mov_b64 exec, 1
    ds_add_u32 v252, v253 offset:72
    s_mov_b64 exec, -1
    v_readfirstlane_b32 s61, v17
    s_nop 3
    s_cmp_lt_u32 s61, 4
    s_cbranch_scc1 XS_1057
XB_1058:
    v_mfma_f32_16x16x32_bf16 v[92:95], v[76:79], v[52:55], v[92:95]
    ds_read_b64_tr_b16 v[64:65], v4 offset:6144
    ds_read_b64_tr_b16 v[66:67], v4 offset:6912
    v_mfma_f32_16x16x32_bf16 v[108:111], v[80:83], v[52:55], v[108:111]
    ds_read_b64_tr_b16 v[68:69], v4 offset:6176
    ds_read_b64_tr_b16 v[70:71], v4 offset:6944
    v_mfma_f32_16x16x32_bf16 v[124:127], v[84:87], v[52:55], v[124:127]
    ds_read_b64_tr_b16 v[72:73], v4 offset:6208
    ds_read_b64_tr_b16 v[74:75], v4 offset:6976
    v_mfma_f32_16x16x32_bf16 v[96:99], v[76:79], v[56:59], v[96:99]
    ds_read_b128 v[32:35], v5 offset:8192
    ds_read_b128 v[36:39], v5 offset:10240
    v_mfma_f32_16x16x32_bf16 v[112:115], v[80:83], v[56:59], v[112:115]
    ds_read_b128 v[40:43], v5 offset:12288
    ds_read_b128 v[44:47], v5 offset:14336
    v_mfma_f32_16x16x32_bf16 v[128:131], v[84:87], v[56:59], v[128:131]
    v_mfma_f32_16x16x32_bf16 v[100:103], v[76:79], v[60:63], v[100:103]
    v_mfma_f32_16x16x32_bf16 v[116:119], v[80:83], v[60:63], v[116:119]
    v_mfma_f32_16x16x32_bf16 v[132:135], v[84:87], v[60:63], v[132:135]
    s_waitcnt lgkmcnt(0)
    v_mfma_f32_16x16x32_bf16 v[88:91], v[64:67], v[32:35], v[88:91]
    s_add_u32 s62, s50, 4
    s_and_b32 s62, s62, 7
    s_lshl_b32 s62, s62, 7
    s_add_u32 s62, s62, s38
    s_add_u32 m0, s39, 32768
    s_nop 0
    buffer_load_dwordx4 v7, s[4:7], s62 offen lds
    s_add_u32 s62, s62, 262144
    s_add_u32 m0, s39, 33792
    s_nop 0
    buffer_load_dwordx4 v8, s[4:7], s62 offen lds
    s_add_u32 s26, s36, 6
    s_and_b32 s26, s26, 15
    s_mul_i32 s26, s26, 88064
    s_add_u32 s26, s26, s28
    s_add_u32 m0, s27, 6144
    s_nop 0
    buffer_load_dwordx4 v1, s[8:11], s26 offen lds
    v_mfma_f32_16x16x32_bf16 v[104:107], v[68:71], v[32:35], v[104:107]
    s_add_u32 m0, s27, 7168
    s_nop 0
    buffer_load_dwordx4 v2, s[8:11], s26 offen lds
    s_add_u32 m0, s27, 8192
    s_nop 0
    buffer_load_dwordx4 v3, s[8:11], s26 offen lds
    v_mfma_f32_16x16x32_bf16 v[120:123], v[72:75], v[32:35], v[120:123]
    s_waitcnt vmcnt(13)
    ds_read_b64_tr_b16 v[76:77], v4 offset:9216
    v_mfma_f32_16x16x32_bf16 v[92:95], v[64:67], v[36:39], v[92:95]
    ds_read_b64_tr_b16 v[78:79], v4 offset:9984
    ds_read_b64_tr_b16 v[80:81], v4 offset:9248
    v_mfma_f32_16x16x32_bf16 v[108:111], v[68:71], v[36:39], v[108:111]
    ds_read_b64_tr_b16 v[82:83], v4 offset:10016
    ds_read_b64_tr_b16 v[84:85], v4 offset:9280
    v_mfma_f32_16x16x32_bf16 v[124:127], v[72:75], v[36:39], v[124:127]
    ds_read_b64_tr_b16 v[86:87], v4 offset:10048
    ds_read_b128 v[48:51], v6 offset:8192
    v_mfma_f32_16x16x32_bf16 v[96:99], v[64:67], v[40:43], v[96:99]
    ds_read_b128 v[52:55], v6 offset:10240
    ds_read_b128 v[56:59], v6 offset:12288
    v_mfma_f32_16x16x32_bf16 v[112:115], v[68:71], v[40:43], v[112:115]
    ds_read_b128 v[60:63], v6 offset:14336
    ds_read_b32 v17, v252 offset:72
    v_mfma_f32_16x16x32_bf16 v[128:131], v[72:75], v[40:43], v[128:131]
    v_mfma_f32_16x16x32_bf16 v[100:103], v[64:67], v[44:47], v[100:103]
    v_mfma_f32_16x16x32_bf16 v[116:119], v[68:71], v[44:47], v[116:119]
    v_mfma_f32_16x16x32_bf16 v[132:135], v[72:75], v[44:47], v[132:135]
    s_waitcnt lgkmcnt(0)
    v_mfma_f32_16x16x32_bf16 v[88:91], v[76:79], v[48:51], v[88:91]
    s_add_u32 s26, s36, 7
    s_and_b32 s26, s26, 15
    s_mul_i32 s26, s26, 88064
    s_add_u32 s26, s26, s28
    s_add_u32 m0, s27, 9216
    s_nop 0
    buffer_load_dwordx4 v1, s[8:11], s26 offen lds
    s_add_u32 m0, s27, 10240
    s_nop 0
    buffer_load_dwordx4 v2, s[8:11], s26 offen lds
    v_mfma_f32_16x16x32_bf16 v[104:107], v[80:83], v[48:51], v[104:107]
    s_add_u32 m0, s27, 11264
    s_nop 0
    buffer_load_dwordx4 v3, s[8:11], s26 offen lds
    s_waitcnt vmcnt(11)
    v_mfma_f32_16x16x32_bf16 v[120:123], v[84:87], v[48:51], v[120:123]
    s_mov_b64 exec, 1
    ds_add_u32 v252, v253 offset:76
    s_mov_b64 exec, -1
    v_readfirstlane_b32 s61, v17
    s_nop 3
    s_cmp_lt_u32 s61, 4
    s_cbranch_scc1 XS_1059
XB_1060:
    v_mfma_f32_16x16x32_bf16 v[92:95], v[76:79], v[52:55], v[92:95]
    ds_read_b64_tr_b16 v[64:65], v4 offset:0
    ds_read_b64_tr_b16 v[66:67], v4 offset:768
    v_mfma_f32_16x16x32_bf16 v[108:111], v[80:83], v[52:55], v[108:111]
    ds_read_b64_tr_b16 v[68:69], v4 offset:32
    ds_read_b64_tr_b16 v[70:71], v4 offset:800
    v_mfma_f32_16x16x32_bf16 v[124:127], v[84:87], v[52:55], v[124:127]
    ds_read_b64_tr_b16 v[72:73], v4 offset:64
    ds_read_b64_tr_b16 v[74:75], v4 offset:832
    v_mfma_f32_16x16x32_bf16 v[96:99], v[76:79], v[56:59], v[96:99]
    ds_read_b128 v[32:35], v5 offset:16384
    ds_read_b128 v[36:39], v5 offset:18432
    v_mfma_f32_16x16x32_bf16 v[112:115], v[80:83], v[56:59], v[112:115]
    ds_read_b128 v[40:43], v5 offset:20480
    ds_read_b128 v[44:47], v5 offset:22528
    v_mfma_f32_16x16x32_bf16 v[128:131], v[84:87], v[56:59], v[128:131]
    v_mfma_f32_16x16x32_bf16 v[100:103], v[76:79], v[60:63], v[100:103]
    v_mfma_f32_16x16x32_bf16 v[116:119], v[80:83], v[60:63], v[116:119]
    v_mfma_f32_16x16x32_bf16 v[132:135], v[84:87], v[60:63], v[132:135]
    s_waitcnt lgkmcnt(0)
    v_mfma_f32_16x16x32_bf16 v[88:91], v[64:67], v[32:35], v[88:91]
    s_add_u32 s62, s50, 5
    s_and_b32 s62, s62, 7
    s_lshl_b32 s62, s62, 7
    s_add_u32 s62, s62, s38
    s_add_u32 m0, s39, 40960
    s_nop 0
    buffer_load_dwordx4 v7, s[4:7], s62 offen lds
    s_add_u32 s62, s62, 262144
    s_add_u32 m0, s39, 41984
    s_nop 0
    buffer_load_dwordx4 v8, s[4:7], s62 offen lds
    s_add_u32 s26, s36, 8
    s_and_b32 s26, s26, 15
    s_mul_i32 s26, s26, 88064
    s_add_u32 s26, s26, s28
    s_add_u32 m0, s27, 0
    s_nop 0
    buffer_load_dwordx4 v1, s[8:11], s26 offen lds
    v_mfma_f32_16x16x32_bf16 v[104:107], v[68:71], v[32:35], v[104:107]
    s_add_u32 m0, s27, 1024
    s_nop 0
    buffer_load_dwordx4 v2, s[8:11], s26 offen lds
    s_add_u32 m0, s27, 2048
    s_nop 0
    buffer_load_dwordx4 v3, s[8:11], s26 offen lds
    v_mfma_f32_16x16x32_bf16 v[120:123], v[72:75], v[32:35], v[120:123]
    s_waitcnt vmcnt(13)
    ds_read_b64_tr_b16 v[76:77], v4 offset:3072
    v_mfma_f32_16x16x32_bf16 v[92:95], v[64:67], v[36:39], v[92:95]
    ds_read_b64_tr_b16 v[78:79], v4 offset:3840
    ds_read_b64_tr_b16 v[80:81], v4 offset:3104
    v_mfma_f32_16x16x32_bf16 v[108:111], v[68:71], v[36:39], v[108:111]
    ds_read_b64_tr_b16 v[82:83], v4 offset:3872
    ds_read_b64_tr_b16 v[84:85], v4 offset:3136
    v_mfma_f32_16x16x32_bf16 v[124:127], v[72:75], v[36:39], v[124:127]
    ds_read_b64_tr_b16 v[86:87], v4 offset:3904
    ds_read_b128 v[48:51], v6 offset:16384
    v_mfma_f32_16x16x32_bf16 v[96:99], v[64:67], v[40:43], v[96:99]
    ds_read_b128 v[52:55], v6 offset:18432
    ds_read_b128 v[56:59], v6 offset:20480
    v_mfma_f32_16x16x32_bf16 v[112:115], v[68:71], v[40:43], v[112:115]
    ds_read_b128 v[60:63], v6 offset:22528
    ds_read_b32 v17, v252 offset:76
    v_mfma_f32_16x16x32_bf16 v[128:131], v[72:75], v[40:43], v[128:131]
    v_mfma_f32_16x16x32_bf16 v[100:103], v[64:67], v[44:47], v[100:103]
    v_mfma_f32_16x16x32_bf16 v[116:119], v[68:71], v[44:47], v[116:119]
    v_mfma_f32_16x16x32_bf16 v[132:135], v[72:75], v[44:47], v[132:135]
    s_waitcnt lgkmcnt(0)
    v_mfma_f32_16x16x32_bf16 v[88:91], v[76:79], v[48:51], v[88:91]
    s_add_u32 s26, s36, 9
    s_and_b32 s26, s26, 15
    s_mul_i32 s26, s26, 88064
    s_add_u32 s26, s26, s28
    s_add_u32 m0, s27, 3072
    s_nop 0
    buffer_load_dwordx4 v1, s[8:11], s26 offen lds
    s_add_u32 m0, s27, 4096
    s_nop 0
    buffer_load_dwordx4 v2, s[8:11], s26 offen lds
    v_mfma_f32_16x16x32_bf16 v[104:107], v[80:83], v[48:51], v[104:107]
    s_add_u32 m0, s27, 5120
    s_nop 0
    buffer_load_dwordx4 v3, s[8:11], s26 offen lds
    s_waitcnt vmcnt(11)
    v_mfma_f32_16x16x32_bf16 v[120:123], v[84:87], v[48:51], v[120:123]
    s_mov_b64 exec, 1
    ds_add_u32 v252, v253 offset:80
    s_mov_b64 exec, -1
    v_readfirstlane_b32 s61, v17
    s_nop 3
    s_cmp_lt_u32 s61, 4
    s_cbranch_scc1 XS_1061
XB_1062:
    v_mfma_f32_16x16x32_bf16 v[92:95], v[76:79], v[52:55], v[92:95]
    ds_read_b64_tr_b16 v[64:65], v4 offset:6144
    ds_read_b64_tr_b16 v[66:67], v4 offset:6912
    v_mfma_f32_16x16x32_bf16 v[108:111], v[80:83], v[52:55], v[108:111]
    ds_read_b64_tr_b16 v[68:69], v4 offset:6176
    ds_read_b64_tr_b16 v[70:71], v4 offset:6944
    v_mfma_f32_16x16x32_bf16 v[124:127], v[84:87], v[52:55], v[124:127]
    ds_read_b64_tr_b16 v[72:73], v4 offset:6208
    ds_read_b64_tr_b16 v[74:75], v4 offset:6976
    v_mfma_f32_16x16x32_bf16 v[96:99], v[76:79], v[56:59], v[96:99]
    ds_read_b128 v[32:35], v5 offset:24576
    ds_read_b128 v[36:39], v5 offset:26624
    v_mfma_f32_16x16x32_bf16 v[112:115], v[80:83], v[56:59], v[112:115]
    ds_read_b128 v[40:43], v5 offset:28672
    ds_read_b128 v[44:47], v5 offset:30720
    v_mfma_f32_16x16x32_bf16 v[128:131], v[84:87], v[56:59], v[128:131]
    v_mfma_f32_16x16x32_bf16 v[100:103], v[76:79], v[60:63], v[100:103]
    v_mfma_f32_16x16x32_bf16 v[116:119], v[80:83], v[60:63], v[116:119]
    v_mfma_f32_16x16x32_bf16 v[132:135], v[84:87], v[60:63], v[132:135]
    s_waitcnt lgkmcnt(0)
    v_mfma_f32_16x16x32_bf16 v[88:91], v[64:67], v[32:35], v[88:91]
    s_add_u32 s54, s55, 0
    buffer_load_dword v250, v248, s[40:43], s54 offen
    s_add_u32 s62, s50, 6
    s_and_b32 s62, s62, 7
    s_lshl_b32 s62, s62, 7
    s_add_u32 s62, s62, s38
    s_add_u32 m0, s39, 49152
    s_nop 0
    buffer_load_dwordx4 v7, s[4:7], s62 offen lds
    s_add_u32 s62, s62, 262144
    s_add_u32 m0, s39, 50176
    s_nop 0
    buffer_load_dwordx4 v8, s[4:7], s62 offen lds
    v_mfma_f32_16x16x32_bf16 v[104:107], v[68:71], v[32:35], v[104:107]
    s_add_u32 s26, s36, 10
    s_and_b32 s26, s26, 15
    s_mul_i32 s26, s26, 88064
    s_add_u32 s26, s26, s28
    s_add_u32 m0, s27, 6144
    s_nop 0
    buffer_load_dwordx4 v1, s[8:11], s26 offen lds
    s_add_u32 m0, s27, 7168
    s_nop 0
    buffer_load_dwordx4 v2, s[8:11], s26 offen lds
    v_mfma_f32_16x16x32_bf16 v[120:123], v[72:75], v[32:35], v[120:123]
    s_add_u32 m0, s27, 8192
    s_nop 0
    buffer_load_dwordx4 v3, s[8:11], s26 offen lds
    s_waitcnt vmcnt(14)
    v_mfma_f32_16x16x32_bf16 v[92:95], v[64:67], v[36:39], v[92:95]
    ds_read_b64_tr_b16 v[76:77], v4 offset:9216
    ds_read_b64_tr_b16 v[78:79], v4 offset:9984
    v_mfma_f32_16x16x32_bf16 v[108:111], v[68:71], v[36:39], v[108:111]
    ds_read_b64_tr_b16 v[80:81], v4 offset:9248
    ds_read_b64_tr_b16 v[82:83], v4 offset:10016
    ds_read_b64_tr_b16 v[84:85], v4 offset:9280
    v_mfma_f32_16x16x32_bf16 v[124:127], v[72:75], v[36:39], v[124:127]
    ds_read_b64_tr_b16 v[86:87], v4 offset:10048
    ds_read_b128 v[48:51], v6 offset:24576
    v_mfma_f32_16x16x32_bf16 v[96:99], v[64:67], v[40:43], v[96:99]
    ds_read_b128 v[52:55], v6 offset:26624
    ds_read_b128 v[56:59], v6 offset:28672
    v_mfma_f32_16x16x32_bf16 v[112:115], v[68:71], v[40:43], v[112:115]
    ds_read_b128 v[60:63], v6 offset:30720
    ds_read_b32 v17, v252 offset:80
    v_mfma_f32_16x16x32_bf16 v[128:131], v[72:75], v[40:43], v[128:131]
    v_mfma_f32_16x16x32_bf16 v[100:103], v[64:67], v[44:47], v[100:103]
    v_mfma_f32_16x16x32_bf16 v[116:119], v[68:71], v[44:47], v[116:119]
    v_mfma_f32_16x16x32_bf16 v[132:135], v[72:75], v[44:47], v[132:135]
    s_waitcnt lgkmcnt(0)
    v_mfma_f32_16x16x32_bf16 v[88:91], v[76:79], v[48:51], v[88:91]
    s_add_u32 s54, s55, 1024
    buffer_load_dword v250, v248, s[40:43], s54 offen
    s_add_u32 s26, s36, 11
    s_and_b32 s26, s26, 15
    s_mul_i32 s26, s26, 88064
    s_add_u32 s26, s26, s28
    s_add_u32 m0, s27, 9216
    s_nop 0
    buffer_load_dwordx4 v1, s[8:11], s26 offen lds
    s_add_u32 m0, s27, 10240
    s_nop 0
    buffer_load_dwordx4 v2, s[8:11], s26 offen lds
    v_mfma_f32_16x16x32_bf16 v[104:107], v[80:83], v[48:51], v[104:107]
    s_add_u32 m0, s27, 11264
    s_nop 0
    buffer_load_dwordx4 v3, s[8:11], s26 offen lds
    s_waitcnt vmcnt(13)
    v_mfma_f32_16x16x32_bf16 v[120:123], v[84:87], v[48:51], v[120:123]
    s_mov_b64 exec, 1
    ds_add_u32 v252, v253 offset:84
    s_mov_b64 exec, -1
    v_readfirstlane_b32 s61, v17
    s_nop 3
    s_cmp_lt_u32 s61, 4
    s_cbranch_scc1 XS_1063
XB_1064:
    v_mfma_f32_16x16x32_bf16 v[92:95], v[76:79], v[52:55], v[92:95]
    ds_read_b64_tr_b16 v[64:65], v4 offset:0
    ds_read_b64_tr_b16 v[66:67], v4 offset:768
    v_mfma_f32_16x16x32_bf16 v[108:111], v[80:83], v[52:55], v[108:111]
    ds_read_b64_tr_b16 v[68:69], v4 offset:32
    ds_read_b64_tr_b16 v[70:71], v4 offset:800
    v_mfma_f32_16x16x32_bf16 v[124:127], v[84:87], v[52:55], v[124:127]
    ds_read_b64_tr_b16 v[72:73], v4 offset:64
    ds_read_b64_tr_b16 v[74:75], v4 offset:832
    v_mfma_f32_16x16x32_bf16 v[96:99], v[76:79], v[56:59], v[96:99]
    ds_read_b128 v[32:35], v5 offset:32768
    ds_read_b128 v[36:39], v5 offset:34816
    v_mfma_f32_16x16x32_bf16 v[112:115], v[80:83], v[56:59], v[112:115]
    ds_read_b128 v[40:43], v5 offset:36864
    ds_read_b128 v[44:47], v5 offset:38912
    v_mfma_f32_16x16x32_bf16 v[128:131], v[84:87], v[56:59], v[128:131]
    v_mfma_f32_16x16x32_bf16 v[100:103], v[76:79], v[60:63], v[100:103]
    v_mfma_f32_16x16x32_bf16 v[116:119], v[80:83], v[60:63], v[116:119]
    v_mfma_f32_16x16x32_bf16 v[132:135], v[84:87], v[60:63], v[132:135]
    s_waitcnt lgkmcnt(0)
    v_mfma_f32_16x16x32_bf16 v[88:91], v[64:67], v[32:35], v[88:91]
    s_add_u32 s54, s55, 2048
    buffer_load_dword v250, v248, s[40:43], s54 offen
    s_add_u32 s62, s50, 7
    s_and_b32 s62, s62, 7
    s_lshl_b32 s62, s62, 7
    s_add_u32 s62, s62, s38
    s_add_u32 m0, s39, 57344
    s_nop 0
    buffer_load_dwordx4 v7, s[4:7], s62 offen lds
    s_add_u32 s62, s62, 262144
    s_add_u32 m0, s39, 58368
    s_nop 0
    buffer_load_dwordx4 v8, s[4:7], s62 offen lds
    v_mfma_f32_16x16x32_bf16 v[104:107], v[68:71], v[32:35], v[104:107]
    s_add_u32 s26, s36, 12
    s_and_b32 s26, s26, 15
    s_mul_i32 s26, s26, 88064
    s_add_u32 s26, s26, s28
    s_add_u32 m0, s27, 0
    s_nop 0
    buffer_load_dwordx4 v1, s[8:11], s26 offen lds
    s_add_u32 m0, s27, 1024
    s_nop 0
    buffer_load_dwordx4 v2, s[8:11], s26 offen lds
    v_mfma_f32_16x16x32_bf16 v[120:123], v[72:75], v[32:35], v[120:123]
    s_add_u32 m0, s27, 2048
    s_nop 0
    buffer_load_dwordx4 v3, s[8:11], s26 offen lds
    s_waitcnt vmcnt(16)
    v_mfma_f32_16x16x32_bf16 v[92:95], v[64:67], v[36:39], v[92:95]
    ds_read_b64_tr_b16 v[76:77], v4 offset:3072
    ds_read_b64_tr_b16 v[78:79], v4 offset:3840
    v_mfma_f32_16x16x32_bf16 v[108:111], v[68:71], v[36:39], v[108:111]
    ds_read_b64_tr_b16 v[80:81], v4 offset:3104
    ds_read_b64_tr_b16 v[82:83], v4 offset:3872
    ds_read_b64_tr_b16 v[84:85], v4 offset:3136
    v_mfma_f32_16x16x32_bf16 v[124:127], v[72:75], v[36:39], v[124:127]
    ds_read_b64_tr_b16 v[86:87], v4 offset:3904
    ds_read_b128 v[48:51], v6 offset:32768
    v_mfma_f32_16x16x32_bf16 v[96:99], v[64:67], v[40:43], v[96:99]
    ds_read_b128 v[52:55], v6 offset:34816
    ds_read_b128 v[56:59], v6 offset:36864
    v_mfma_f32_16x16x32_bf16 v[112:115], v[68:71], v[40:43], v[112:115]
    ds_read_b128 v[60:63], v6 offset:38912
    ds_read_b32 v17, v252 offset:84
    v_mfma_f32_16x16x32_bf16 v[128:131], v[72:75], v[40:43], v[128:131]
    v_mfma_f32_16x16x32_bf16 v[100:103], v[64:67], v[44:47], v[100:103]
    v_mfma_f32_16x16x32_bf16 v[116:119], v[68:71], v[44:47], v[116:119]
    v_mfma_f32_16x16x32_bf16 v[132:135], v[72:75], v[44:47], v[132:135]
    s_waitcnt lgkmcnt(0)
    v_mfma_f32_16x16x32_bf16 v[88:91], v[76:79], v[48:51], v[88:91]
    s_add_u32 s54, s55, 3072
    buffer_load_dword v250, v248, s[40:43], s54 offen
    s_add_u32 s26, s36, 13
    s_and_b32 s26, s26, 15
    s_mul_i32 s26, s26, 88064
    s_add_u32 s26, s26, s28
    s_add_u32 m0, s27, 3072
    s_nop 0
    buffer_load_dwordx4 v1, s[8:11], s26 offen lds
    s_add_u32 m0, s27, 4096
    s_nop 0
    buffer_load_dwordx4 v2, s[8:11], s26 offen lds
    v_mfma_f32_16x16x32_bf16 v[104:107], v[80:83], v[48:51], v[104:107]
    s_add_u32 m0, s27, 5120
    s_nop 0
    buffer_load_dwordx4 v3, s[8:11], s26 offen lds
    s_waitcnt vmcnt(14)
    v_mfma_f32_16x16x32_bf16 v[120:123], v[84:87], v[48:51], v[120:123]
    s_mov_b64 exec, 1
    ds_add_u32 v252, v253 offset:88
    s_mov_b64 exec, -1
    v_readfirstlane_b32 s61, v17
    s_nop 3
    s_cmp_lt_u32 s61, 4
    s_cbranch_scc1 XS_1065
XB_1066:
    v_mfma_f32_16x16x32_bf16 v[92:95], v[76:79], v[52:55], v[92:95]
    ds_read_b64_tr_b16 v[64:65], v4 offset:6144
    ds_read_b64_tr_b16 v[66:67], v4 offset:6912
    v_mfma_f32_16x16x32_bf16 v[108:111], v[80:83], v[52:55], v[108:111]
    ds_read_b64_tr_b16 v[68:69], v4 offset:6176
    ds_read_b64_tr_b16 v[70:71], v4 offset:6944
    v_mfma_f32_16x16x32_bf16 v[124:127], v[84:87], v[52:55], v[124:127]
    ds_read_b64_tr_b16 v[72:73], v4 offset:6208
    ds_read_b64_tr_b16 v[74:75], v4 offset:6976
    v_mfma_f32_16x16x32_bf16 v[96:99], v[76:79], v[56:59], v[96:99]
    ds_read_b128 v[32:35], v5 offset:40960
    ds_read_b128 v[36:39], v5 offset:43008
    v_mfma_f32_16x16x32_bf16 v[112:115], v[80:83], v[56:59], v[112:115]
    ds_read_b128 v[40:43], v5 offset:45056
    ds_read_b128 v[44:47], v5 offset:47104
    v_mfma_f32_16x16x32_bf16 v[128:131], v[84:87], v[56:59], v[128:131]
    v_mfma_f32_16x16x32_bf16 v[100:103], v[76:79], v[60:63], v[100:103]
    v_mfma_f32_16x16x32_bf16 v[116:119], v[80:83], v[60:63], v[116:119]
    v_mfma_f32_16x16x32_bf16 v[132:135], v[84:87], v[60:63], v[132:135]
    s_waitcnt lgkmcnt(0)
    v_mfma_f32_16x16x32_bf16 v[88:91], v[64:67], v[32:35], v[88:91]
    s_add_u32 s26, s36, 14
    s_and_b32 s26, s26, 15
    s_mul_i32 s26, s26, 88064
    s_add_u32 s26, s26, s28
    s_add_u32 m0, s27, 6144
    s_nop 0
    buffer_load_dwordx4 v1, s[8:11], s26 offen lds
    s_add_u32 m0, s27, 7168
    s_nop 0
    buffer_load_dwordx4 v2, s[8:11], s26 offen lds
    v_mfma_f32_16x16x32_bf16 v[104:107], v[68:71], v[32:35], v[104:107]
    s_add_u32 m0, s27, 8192
    s_nop 0
    buffer_load_dwordx4 v3, s[8:11], s26 offen lds
    s_waitcnt vmcnt(13)
    v_mfma_f32_16x16x32_bf16 v[120:123], v[72:75], v[32:35], v[120:123]
    ds_read_b64_tr_b16 v[76:77], v4 offset:9216
    ds_read_b64_tr_b16 v[78:79], v4 offset:9984
    v_mfma_f32_16x16x32_bf16 v[92:95], v[64:67], v[36:39], v[92:95]
    ds_read_b64_tr_b16 v[80:81], v4 offset:9248
    ds_read_b64_tr_b16 v[82:83], v4 offset:10016
    v_mfma_f32_16x16x32_bf16 v[108:111], v[68:71], v[36:39], v[108:111]
    ds_read_b64_tr_b16 v[84:85], v4 offset:9280
    ds_read_b64_tr_b16 v[86:87], v4 offset:10048
    v_mfma_f32_16x16x32_bf16 v[124:127], v[72:75], v[36:39], v[124:127]
    ds_read_b128 v[48:51], v6 offset:40960
    ds_read_b128 v[52:55], v6 offset:43008
    v_mfma_f32_16x16x32_bf16 v[96:99], v[64:67], v[40:43], v[96:99]
    ds_read_b128 v[56:59], v6 offset:45056
    ds_read_b128 v[60:63], v6 offset:47104
    v_mfma_f32_16x16x32_bf16 v[112:115], v[68:71], v[40:43], v[112:115]
    ds_read_b32 v17, v252 offset:88
    v_mfma_f32_16x16x32_bf16 v[128:131], v[72:75], v[40:43], v[128:131]
    v_mfma_f32_16x16x32_bf16 v[100:103], v[64:67], v[44:47], v[100:103]
    v_mfma_f32_16x16x32_bf16 v[116:119], v[68:71], v[44:47], v[116:119]
    v_mfma_f32_16x16x32_bf16 v[132:135], v[72:75], v[44:47], v[132:135]
    s_waitcnt lgkmcnt(0)
    v_mfma_f32_16x16x32_bf16 v[88:91], v[76:79], v[48:51], v[88:91]
    s_mov_b64 exec, 1
    ds_add_u32 v252, v253 offset:40
    s_mov_b64 exec, -1
    s_add_u32 s26, s36, 15
    s_and_b32 s26, s26, 15
    s_mul_i32 s26, s26, 88064
    s_add_u32 s26, s26, s28
    s_add_u32 m0, s27, 9216
    s_nop 0
    buffer_load_dwordx4 v1, s[8:11], s26 offen lds
    s_add_u32 m0, s27, 10240
    s_nop 0
    buffer_load_dwordx4 v2, s[8:11], s26 offen lds
    v_mfma_f32_16x16x32_bf16 v[104:107], v[80:83], v[48:51], v[104:107]
    s_add_u32 m0, s27, 11264
    s_nop 0
    buffer_load_dwordx4 v3, s[8:11], s26 offen lds
    s_waitcnt vmcnt(10)
    v_mfma_f32_16x16x32_bf16 v[120:123], v[84:87], v[48:51], v[120:123]
    s_mov_b64 exec, 1
    ds_add_u32 v252, v253 offset:92
    s_mov_b64 exec, -1
    v_readfirstlane_b32 s61, v17
    s_nop 3
    s_cmp_lt_u32 s61, 4
    s_cbranch_scc1 XS_1067
XB_1068:
    v_mfma_f32_16x16x32_bf16 v[92:95], v[76:79], v[52:55], v[92:95]
    ds_read_b64_tr_b16 v[64:65], v4 offset:0
    ds_read_b64_tr_b16 v[66:67], v4 offset:768
    v_mfma_f32_16x16x32_bf16 v[108:111], v[80:83], v[52:55], v[108:111]
    ds_read_b64_tr_b16 v[68:69], v4 offset:32
    ds_read_b64_tr_b16 v[70:71], v4 offset:800
    v_mfma_f32_16x16x32_bf16 v[124:127], v[84:87], v[52:55], v[124:127]
    ds_read_b64_tr_b16 v[72:73], v4 offset:64
    ds_read_b64_tr_b16 v[74:75], v4 offset:832
    v_mfma_f32_16x16x32_bf16 v[96:99], v[76:79], v[56:59], v[96:99]
    ds_read_b128 v[32:35], v5 offset:49152
    ds_read_b128 v[36:39], v5 offset:51200
    v_mfma_f32_16x16x32_bf16 v[112:115], v[80:83], v[56:59], v[112:115]
    ds_read_b128 v[40:43], v5 offset:53248
    ds_read_b128 v[44:47], v5 offset:55296
    v_mfma_f32_16x16x32_bf16 v[128:131], v[84:87], v[56:59], v[128:131]
    v_mfma_f32_16x16x32_bf16 v[100:103], v[76:79], v[60:63], v[100:103]
    v_mfma_f32_16x16x32_bf16 v[116:119], v[80:83], v[60:63], v[116:119]
    v_mfma_f32_16x16x32_bf16 v[132:135], v[84:87], v[60:63], v[132:135]
    s_waitcnt lgkmcnt(0)
    v_mfma_f32_16x16x32_bf16 v[88:91], v[64:67], v[32:35], v[88:91]
    s_waitcnt vmcnt(6)
    ds_read_b64_tr_b16 v[76:77], v4 offset:3072
    v_mfma_f32_16x16x32_bf16 v[104:107], v[68:71], v[32:35], v[104:107]
    ds_read_b64_tr_b16 v[78:79], v4 offset:3840
    v_mfma_f32_16x16x32_bf16 v[120:123], v[72:75], v[32:35], v[120:123]
    ds_read_b64_tr_b16 v[80:81], v4 offset:3104
    ds_read_b64_tr_b16 v[82:83], v4 offset:3872
    v_mfma_f32_16x16x32_bf16 v[92:95], v[64:67], v[36:39], v[92:95]
    ds_read_b64_tr_b16 v[84:85], v4 offset:3136
    v_mfma_f32_16x16x32_bf16 v[108:111], v[68:71], v[36:39], v[108:111]
    ds_read_b64_tr_b16 v[86:87], v4 offset:3904
    ds_read_b128 v[48:51], v6 offset:49152
    v_mfma_f32_16x16x32_bf16 v[124:127], v[72:75], v[36:39], v[124:127]
    ds_read_b128 v[52:55], v6 offset:51200
    v_mfma_f32_16x16x32_bf16 v[96:99], v[64:67], v[40:43], v[96:99]
    ds_read_b128 v[56:59], v6 offset:53248
    ds_read_b128 v[60:63], v6 offset:55296
    v_mfma_f32_16x16x32_bf16 v[112:115], v[68:71], v[40:43], v[112:115]
    ds_read_b32 v17, v252 offset:92
    v_mfma_f32_16x16x32_bf16 v[128:131], v[72:75], v[40:43], v[128:131]
    v_mfma_f32_16x16x32_bf16 v[100:103], v[64:67], v[44:47], v[100:103]
    v_mfma_f32_16x16x32_bf16 v[116:119], v[68:71], v[44:47], v[116:119]
    v_mfma_f32_16x16x32_bf16 v[132:135], v[72:75], v[44:47], v[132:135]
    s_waitcnt lgkmcnt(0)
    v_mfma_f32_16x16x32_bf16 v[88:91], v[76:79], v[48:51], v[88:91]
    s_waitcnt vmcnt(3)
    v_readfirstlane_b32 s61, v17
    s_nop 3
    s_cmp_lt_u32 s61, 4
    s_cbranch_scc1 XS_1069
XB_1070:
    v_mfma_f32_16x16x32_bf16 v[104:107], v[80:83], v[48:51], v[104:107]
    ds_read_b64_tr_b16 v[64:65], v4 offset:6144
    v_mfma_f32_16x16x32_bf16 v[120:123], v[84:87], v[48:51], v[120:123]
    ds_read_b64_tr_b16 v[66:67], v4 offset:6912
    ds_read_b64_tr_b16 v[68:69], v4 offset:6176
    v_mfma_f32_16x16x32_bf16 v[92:95], v[76:79], v[52:55], v[92:95]
    ds_read_b64_tr_b16 v[70:71], v4 offset:6944
    v_mfma_f32_16x16x32_bf16 v[108:111], v[80:83], v[52:55], v[108:111]
    ds_read_b64_tr_b16 v[72:73], v4 offset:6208
    ds_read_b64_tr_b16 v[74:75], v4 offset:6976
    v_mfma_f32_16x16x32_bf16 v[124:127], v[84:87], v[52:55], v[124:127]
    ds_read_b128 v[32:35], v5 offset:57344
    v_mfma_f32_16x16x32_bf16 v[96:99], v[76:79], v[56:59], v[96:99]
    ds_read_b128 v[36:39], v5 offset:59392
    ds_read_b128 v[40:43], v5 offset:61440
    v_mfma_f32_16x16x32_bf16 v[112:115], v[80:83], v[56:59], v[112:115]
    ds_read_b128 v[44:47], v5 offset:63488
    v_mfma_f32_16x16x32_bf16 v[128:131], v[84:87], v[56:59], v[128:131]
    v_mfma_f32_16x16x32_bf16 v[100:103], v[76:79], v[60:63], v[100:103]
    v_mfma_f32_16x16x32_bf16 v[116:119], v[80:83], v[60:63], v[116:119]
    v_mfma_f32_16x16x32_bf16 v[132:135], v[84:87], v[60:63], v[132:135]
    s_waitcnt lgkmcnt(0)
    v_mfma_f32_16x16x32_bf16 v[88:91], v[64:67], v[32:35], v[88:91]
    s_waitcnt vmcnt(0)
    ds_read_b64_tr_b16 v[76:77], v4 offset:9216
    v_mfma_f32_16x16x32_bf16 v[104:107], v[68:71], v[32:35], v[104:107]
    ds_read_b64_tr_b16 v[78:79], v4 offset:9984
    v_mfma_f32_16x16x32_bf16 v[120:123], v[72:75], v[32:35], v[120:123]
    ds_read_b64_tr_b16 v[80:81], v4 offset:9248
    ds_read_b64_tr_b16 v[82:83], v4 offset:10016
    v_mfma_f32_16x16x32_bf16 v[92:95], v[64:67], v[36:39], v[92:95]
    ds_read_b64_tr_b16 v[84:85], v4 offset:9280
    v_mfma_f32_16x16x32_bf16 v[108:111], v[68:71], v[36:39], v[108:111]
    ds_read_b64_tr_b16 v[86:87], v4 offset:10048
    v_mfma_f32_16x16x32_bf16 v[124:127], v[72:75], v[36:39], v[124:127]
    ds_read_b128 v[48:51], v6 offset:57344
    ds_read_b128 v[52:55], v6 offset:59392
    v_mfma_f32_16x16x32_bf16 v[96:99], v[64:67], v[40:43], v[96:99]
    ds_read_b128 v[56:59], v6 offset:61440
    v_mfma_f32_16x16x32_bf16 v[112:115], v[68:71], v[40:43], v[112:115]
    ds_read_b128 v[60:63], v6 offset:63488
    v_mfma_f32_16x16x32_bf16 v[128:131], v[72:75], v[40:43], v[128:131]
    v_mfma_f32_16x16x32_bf16 v[100:103], v[64:67], v[44:47], v[100:103]
    v_mfma_f32_16x16x32_bf16 v[116:119], v[68:71], v[44:47], v[116:119]
    v_mfma_f32_16x16x32_bf16 v[132:135], v[72:75], v[44:47], v[132:135]
    s_waitcnt lgkmcnt(0)
    v_mfma_f32_16x16x32_bf16 v[88:91], v[76:79], v[48:51], v[88:91]
    s_mov_b64 exec, 1
    ds_add_u32 v252, v253 offset:12
    s_mov_b64 exec, -1
    v_and_b32 v9, 1, v15
    v_mfma_f32_16x16x32_bf16 v[104:107], v[80:83], v[48:51], v[104:107]
    v_lshlrev_b32 v9, 9, v9
    v_lshrrev_b32 v14, 1, v15
    v_mfma_f32_16x16x32_bf16 v[120:123], v[84:87], v[48:51], v[120:123]
    v_lshl_add_u32 v9, v14, 8, v9
    v_lshl_add_u32 v9, v16, 4, v9
    v_mfma_f32_16x16x32_bf16 v[92:95], v[76:79], v[52:55], v[92:95]
    s_mul_i32 s24, s20, 180224
    s_lshl_b32 s25, s22, 11
    v_mfma_f32_16x16x32_bf16 v[108:111], v[80:83], v[52:55], v[108:111]
    s_add_u32 s24, s24, s25
    s_add_u32 s24, s24, 4194304
    v_mfma_f32_16x16x32_bf16 v[124:127], v[84:87], v[52:55], v[124:127]
    v_mov_b32 v34, 1.0
    v_mov_b32 v35, 1.0
    v_mfma_f32_16x16x32_bf16 v[96:99], v[76:79], v[56:59], v[96:99]
    v_mov_b32 v44, 0xc0135761
    v_mov_b32 v46, 0xbdd2d3e8
    v_mfma_f32_16x16x32_bf16 v[112:115], v[80:83], v[56:59], v[112:115]
    v_mov_b32 v45, 0xc0135761
    v_mov_b32 v47, 0xbdd2d3e8
    v_mfma_f32_16x16x32_bf16 v[128:131], v[84:87], v[56:59], v[128:131]
    v_mfma_f32_16x16x32_bf16 v[100:103], v[76:79], v[60:63], v[100:103]
    v_mfma_f32_16x16x32_bf16 v[116:119], v[80:83], v[60:63], v[116:119]
    v_mfma_f32_16x16x32_bf16 v[132:135], v[84:87], v[60:63], v[132:135]
    v_add_u32 v251, 0x9e3779b9, v251
    v_pk_mul_f32 v[36:37], v[88:89], v[88:89]
    v_pk_fma_f32 v[36:37], v[36:37], v[46:47], v[44:45]
    v_pk_mul_f32 v[36:37], v[36:37], v[88:89]
    v_exp_f32 v36, v36
    v_exp_f32 v37, v37
    s_nop 0
    v_pk_add_f32 v[36:37], v[36:37], v[34:35]
    v_rcp_f32 v36, v36
    v_rcp_f32 v37, v37
    s_nop 0
    v_pk_mul_f32 v[36:37], v[36:37], v[88:89]
    v_cvt_pk_bf16_f32 v48, v36, v37
    v_pk_mul_f32 v[38:39], v[90:91], v[90:91]
    v_pk_fma_f32 v[38:39], v[38:39], v[46:47], v[44:45]
    v_pk_mul_f32 v[38:39], v[38:39], v[90:91]
    v_exp_f32 v38, v38
    v_exp_f32 v39, v39
    s_nop 0
    v_pk_add_f32 v[38:39], v[38:39], v[34:35]
    v_rcp_f32 v38, v38
    v_rcp_f32 v39, v39
    s_nop 0
    v_pk_mul_f32 v[38:39], v[38:39], v[90:91]
    v_cvt_pk_bf16_f32 v49, v38, v39
    v_pk_mul_f32 v[40:41], v[92:93], v[92:93]
    v_pk_fma_f32 v[40:41], v[40:41], v[46:47], v[44:45]
    v_pk_mul_f32 v[40:41], v[40:41], v[92:93]
    v_exp_f32 v40, v40
    v_exp_f32 v41, v41
    s_nop 0
    v_pk_add_f32 v[40:41], v[40:41], v[34:35]
    v_rcp_f32 v40, v40
    v_rcp_f32 v41, v41
    s_nop 0
    v_pk_mul_f32 v[40:41], v[40:41], v[92:93]
    v_cvt_pk_bf16_f32 v50, v40, v41
    v_pk_mul_f32 v[42:43], v[94:95], v[94:95]
    v_pk_fma_f32 v[42:43], v[42:43], v[46:47], v[44:45]
    v_pk_mul_f32 v[42:43], v[42:43], v[94:95]
    v_exp_f32 v42, v42
    v_exp_f32 v43, v43
    s_nop 0
    v_pk_add_f32 v[42:43], v[42:43], v[34:35]
    v_rcp_f32 v42, v42
    v_rcp_f32 v43, v43
    s_nop 0
    v_pk_mul_f32 v[42:43], v[42:43], v[94:95]
    v_cvt_pk_bf16_f32 v51, v42, v43
    v_pk_mul_f32 v[36:37], v[96:97], v[96:97]
    v_pk_fma_f32 v[36:37], v[36:37], v[46:47], v[44:45]
    v_pk_mul_f32 v[36:37], v[36:37], v[96:97]
    v_exp_f32 v36, v36
    v_exp_f32 v37, v37
    s_nop 0
    v_pk_add_f32 v[36:37], v[36:37], v[34:35]
    v_rcp_f32 v36, v36
    v_rcp_f32 v37, v37
    s_nop 0
    v_pk_mul_f32 v[36:37], v[36:37], v[96:97]
    v_cvt_pk_bf16_f32 v52, v36, v37
    v_pk_mul_f32 v[38:39], v[98:99], v[98:99]
    v_pk_fma_f32 v[38:39], v[38:39], v[46:47], v[44:45]
    v_pk_mul_f32 v[38:39], v[38:39], v[98:99]
    v_exp_f32 v38, v38
    v_exp_f32 v39, v39
    s_nop 0
    v_pk_add_f32 v[38:39], v[38:39], v[34:35]
    v_rcp_f32 v38, v38
    v_rcp_f32 v39, v39
    s_nop 0
    v_pk_mul_f32 v[38:39], v[38:39], v[98:99]
    v_cvt_pk_bf16_f32 v53, v38, v39
    v_pk_mul_f32 v[40:41], v[100:101], v[100:101]
    v_pk_fma_f32 v[40:41], v[40:41], v[46:47], v[44:45]
    v_pk_mul_f32 v[40:41], v[40:41], v[100:101]
    v_exp_f32 v40, v40
    v_exp_f32 v41, v41
    s_nop 0
    v_pk_add_f32 v[40:41], v[40:41], v[34:35]
    v_rcp_f32 v40, v40
    v_rcp_f32 v41, v41
    s_nop 0
    v_pk_mul_f32 v[40:41], v[40:41], v[100:101]
    v_cvt_pk_bf16_f32 v54, v40, v41
    v_pk_mul_f32 v[42:43], v[102:103], v[102:103]
    v_pk_fma_f32 v[42:43], v[42:43], v[46:47], v[44:45]
    v_pk_mul_f32 v[42:43], v[42:43], v[102:103]
    v_exp_f32 v42, v42
    v_exp_f32 v43, v43
    s_nop 0
    v_pk_add_f32 v[42:43], v[42:43], v[34:35]
    v_rcp_f32 v42, v42
    v_rcp_f32 v43, v43
    s_nop 0
    v_pk_mul_f32 v[42:43], v[42:43], v[102:103]
    v_cvt_pk_bf16_f32 v55, v42, v43
    v_permlane16_swap_b32 v48, v50
    v_permlane16_swap_b32 v49, v51
    s_add_u32 s25, s24, 0
    buffer_store_dwordx4 v[48:51], v9, s[12:15], s25 offen sc1
    v_permlane16_swap_b32 v52, v54
    v_permlane16_swap_b32 v53, v55
    s_add_u32 s25, s24, 1024
    buffer_store_dwordx4 v[52:55], v9, s[12:15], s25 offen sc1
    s_nop 2
    s_cmp_le_u32 s23, 1
    s_cbranch_scc1 B1skip_1071
    v_pk_mul_f32 v[36:37], v[104:105], v[104:105]
    v_pk_fma_f32 v[36:37], v[36:37], v[46:47], v[44:45]
    v_pk_mul_f32 v[36:37], v[36:37], v[104:105]
    v_exp_f32 v36, v36
    v_exp_f32 v37, v37
    s_nop 0
    v_pk_add_f32 v[36:37], v[36:37], v[34:35]
    v_rcp_f32 v36, v36
    v_rcp_f32 v37, v37
    s_nop 0
    v_pk_mul_f32 v[36:37], v[36:37], v[104:105]
    v_cvt_pk_bf16_f32 v56, v36, v37
    v_pk_mul_f32 v[38:39], v[106:107], v[106:107]
    v_pk_fma_f32 v[38:39], v[38:39], v[46:47], v[44:45]
    v_pk_mul_f32 v[38:39], v[38:39], v[106:107]
    v_exp_f32 v38, v38
    v_exp_f32 v39, v39
    s_nop 0
    v_pk_add_f32 v[38:39], v[38:39], v[34:35]
    v_rcp_f32 v38, v38
    v_rcp_f32 v39, v39
    s_nop 0
    v_pk_mul_f32 v[38:39], v[38:39], v[106:107]
    v_cvt_pk_bf16_f32 v57, v38, v39
    v_pk_mul_f32 v[40:41], v[108:109], v[108:109]
    v_pk_fma_f32 v[40:41], v[40:41], v[46:47], v[44:45]
    v_pk_mul_f32 v[40:41], v[40:41], v[108:109]
    v_exp_f32 v40, v40
    v_exp_f32 v41, v41
    s_nop 0
    v_pk_add_f32 v[40:41], v[40:41], v[34:35]
    v_rcp_f32 v40, v40
    v_rcp_f32 v41, v41
    s_nop 0
    v_pk_mul_f32 v[40:41], v[40:41], v[108:109]
    v_cvt_pk_bf16_f32 v58, v40, v41
    v_pk_mul_f32 v[42:43], v[110:111], v[110:111]
    v_pk_fma_f32 v[42:43], v[42:43], v[46:47], v[44:45]
    v_pk_mul_f32 v[42:43], v[42:43], v[110:111]
    v_exp_f32 v42, v42
    v_exp_f32 v43, v43
    s_nop 0
    v_pk_add_f32 v[42:43], v[42:43], v[34:35]
    v_rcp_f32 v42, v42
    v_rcp_f32 v43, v43
    s_nop 0
    v_pk_mul_f32 v[42:43], v[42:43], v[110:111]
    v_cvt_pk_bf16_f32 v59, v42, v43
    v_pk_mul_f32 v[36:37], v[112:113], v[112:113]
    v_pk_fma_f32 v[36:37], v[36:37], v[46:47], v[44:45]
    v_pk_mul_f32 v[36:37], v[36:37], v[112:113]
    v_exp_f32 v36, v36
    v_exp_f32 v37, v37
    s_nop 0
    v_pk_add_f32 v[36:37], v[36:37], v[34:35]
    v_rcp_f32 v36, v36
    v_rcp_f32 v37, v37
    s_nop 0
    v_pk_mul_f32 v[36:37], v[36:37], v[112:113]
    v_cvt_pk_bf16_f32 v60, v36, v37
    v_pk_mul_f32 v[38:39], v[114:115], v[114:115]
    v_pk_fma_f32 v[38:39], v[38:39], v[46:47], v[44:45]
    v_pk_mul_f32 v[38:39], v[38:39], v[114:115]
    v_exp_f32 v38, v38
    v_exp_f32 v39, v39
    s_nop 0
    v_pk_add_f32 v[38:39], v[38:39], v[34:35]
    v_rcp_f32 v38, v38
    v_rcp_f32 v39, v39
    s_nop 0
    v_pk_mul_f32 v[38:39], v[38:39], v[114:115]
    v_cvt_pk_bf16_f32 v61, v38, v39
    v_pk_mul_f32 v[40:41], v[116:117], v[116:117]
    v_pk_fma_f32 v[40:41], v[40:41], v[46:47], v[44:45]
    v_pk_mul_f32 v[40:41], v[40:41], v[116:117]
    v_exp_f32 v40, v40
    v_exp_f32 v41, v41
    s_nop 0
    v_pk_add_f32 v[40:41], v[40:41], v[34:35]
    v_rcp_f32 v40, v40
    v_rcp_f32 v41, v41
    s_nop 0
    v_pk_mul_f32 v[40:41], v[40:41], v[116:117]
    v_cvt_pk_bf16_f32 v62, v40, v41
    v_pk_mul_f32 v[42:43], v[118:119], v[118:119]
    v_pk_fma_f32 v[42:43], v[42:43], v[46:47], v[44:45]
    v_pk_mul_f32 v[42:43], v[42:43], v[118:119]
    v_exp_f32 v42, v42
    v_exp_f32 v43, v43
    s_nop 0
    v_pk_add_f32 v[42:43], v[42:43], v[34:35]
    v_rcp_f32 v42, v42
    v_rcp_f32 v43, v43
    s_nop 0
    v_pk_mul_f32 v[42:43], v[42:43], v[118:119]
    v_cvt_pk_bf16_f32 v63, v42, v43
    v_permlane16_swap_b32 v56, v58
    v_permlane16_swap_b32 v57, v59
    s_add_u32 s25, s24, 2048
    buffer_store_dwordx4 v[56:59], v9, s[12:15], s25 offen sc1
    v_permlane16_swap_b32 v60, v62
    v_permlane16_swap_b32 v61, v63
    s_add_u32 s25, s24, 3072
    buffer_store_dwordx4 v[60:63], v9, s[12:15], s25 offen sc1
    s_nop 2
    s_cmp_le_u32 s23, 2
    s_cbranch_scc1 B1skip_1072
    v_pk_mul_f32 v[36:37], v[120:121], v[120:121]
    v_pk_fma_f32 v[36:37], v[36:37], v[46:47], v[44:45]
    v_pk_mul_f32 v[36:37], v[36:37], v[120:121]
    v_exp_f32 v36, v36
    v_exp_f32 v37, v37
    s_nop 0
    v_pk_add_f32 v[36:37], v[36:37], v[34:35]
    v_rcp_f32 v36, v36
    v_rcp_f32 v37, v37
    s_nop 0
    v_pk_mul_f32 v[36:37], v[36:37], v[120:121]
    v_cvt_pk_bf16_f32 v48, v36, v37
    v_pk_mul_f32 v[38:39], v[122:123], v[122:123]
    v_pk_fma_f32 v[38:39], v[38:39], v[46:47], v[44:45]
    v_pk_mul_f32 v[38:39], v[38:39], v[122:123]
    v_exp_f32 v38, v38
    v_exp_f32 v39, v39
    s_nop 0
    v_pk_add_f32 v[38:39], v[38:39], v[34:35]
    v_rcp_f32 v38, v38
    v_rcp_f32 v39, v39
    s_nop 0
    v_pk_mul_f32 v[38:39], v[38:39], v[122:123]
    v_cvt_pk_bf16_f32 v49, v38, v39
    v_pk_mul_f32 v[40:41], v[124:125], v[124:125]
    v_pk_fma_f32 v[40:41], v[40:41], v[46:47], v[44:45]
    v_pk_mul_f32 v[40:41], v[40:41], v[124:125]
    v_exp_f32 v40, v40
    v_exp_f32 v41, v41
    s_nop 0
    v_pk_add_f32 v[40:41], v[40:41], v[34:35]
    v_rcp_f32 v40, v40
    v_rcp_f32 v41, v41
    s_nop 0
    v_pk_mul_f32 v[40:41], v[40:41], v[124:125]
    v_cvt_pk_bf16_f32 v50, v40, v41
    v_pk_mul_f32 v[42:43], v[126:127], v[126:127]
    v_pk_fma_f32 v[42:43], v[42:43], v[46:47], v[44:45]
    v_pk_mul_f32 v[42:43], v[42:43], v[126:127]
    v_exp_f32 v42, v42
    v_exp_f32 v43, v43
    s_nop 0
    v_pk_add_f32 v[42:43], v[42:43], v[34:35]
    v_rcp_f32 v42, v42
    v_rcp_f32 v43, v43
    s_nop 0
    v_pk_mul_f32 v[42:43], v[42:43], v[126:127]
    v_cvt_pk_bf16_f32 v51, v42, v43
    v_pk_mul_f32 v[36:37], v[128:129], v[128:129]
    v_pk_fma_f32 v[36:37], v[36:37], v[46:47], v[44:45]
    v_pk_mul_f32 v[36:37], v[36:37], v[128:129]
    v_exp_f32 v36, v36
    v_exp_f32 v37, v37
    s_nop 0
    v_pk_add_f32 v[36:37], v[36:37], v[34:35]
    v_rcp_f32 v36, v36
    v_rcp_f32 v37, v37
    s_nop 0
    v_pk_mul_f32 v[36:37], v[36:37], v[128:129]
    v_cvt_pk_bf16_f32 v52, v36, v37
    v_pk_mul_f32 v[38:39], v[130:131], v[130:131]
    v_pk_fma_f32 v[38:39], v[38:39], v[46:47], v[44:45]
    v_pk_mul_f32 v[38:39], v[38:39], v[130:131]
    v_exp_f32 v38, v38
    v_exp_f32 v39, v39
    s_nop 0
    v_pk_add_f32 v[38:39], v[38:39], v[34:35]
    v_rcp_f32 v38, v38
    v_rcp_f32 v39, v39
    s_nop 0
    v_pk_mul_f32 v[38:39], v[38:39], v[130:131]
    v_cvt_pk_bf16_f32 v53, v38, v39
    v_pk_mul_f32 v[40:41], v[132:133], v[132:133]
    v_pk_fma_f32 v[40:41], v[40:41], v[46:47], v[44:45]
    v_pk_mul_f32 v[40:41], v[40:41], v[132:133]
    v_exp_f32 v40, v40
    v_exp_f32 v41, v41
    s_nop 0
    v_pk_add_f32 v[40:41], v[40:41], v[34:35]
    v_rcp_f32 v40, v40
    v_rcp_f32 v41, v41
    s_nop 0
    v_pk_mul_f32 v[40:41], v[40:41], v[132:133]
    v_cvt_pk_bf16_f32 v54, v40, v41
    v_pk_mul_f32 v[42:43], v[134:135], v[134:135]
    v_pk_fma_f32 v[42:43], v[42:43], v[46:47], v[44:45]
    v_pk_mul_f32 v[42:43], v[42:43], v[134:135]
    v_exp_f32 v42, v42
    v_exp_f32 v43, v43
    s_nop 0
    v_pk_add_f32 v[42:43], v[42:43], v[34:35]
    v_rcp_f32 v42, v42
    v_rcp_f32 v43, v43
    s_nop 0
    v_pk_mul_f32 v[42:43], v[42:43], v[134:135]
    v_cvt_pk_bf16_f32 v55, v42, v43
    v_permlane16_swap_b32 v48, v50
    v_permlane16_swap_b32 v49, v51
    s_add_u32 s25, s24, 4096
    buffer_store_dwordx4 v[48:51], v9, s[12:15], s25 offen sc1
    v_permlane16_swap_b32 v52, v54
    v_permlane16_swap_b32 v53, v55
    s_add_u32 s25, s24, 5120
    buffer_store_dwordx4 v[52:55], v9, s[12:15], s25 offen sc1
    s_nop 2
    s_branch B1end_1073
B1skip_1071:
    s_nop 1
B1skip_1072:
B1end_1073:
    s_and_b32 s30, s2, 7
    s_lshl_b32 s30, s30, 2
    s_lshr_b32 s32, s2, 3
    s_lshr_b32 s31, s32, 2
    s_and_b32 s32, s32, 3
    s_add_u32 s30, s30, s32
    v_lshrrev_b32 v162, 3, v0
    v_bfe_u32 v163, v162, 1, 1
    v_bfe_u32 v164, v0, 1, 2
    v_xor_b32 v163, v163, v164
    v_lshlrev_b32 v163, 5, v163
    v_and_b32 v164, 1, v0
    v_lshl_add_u32 v163, v164, 4, v163
    v_lshl_add_u32 v160, v162, 10, v163
    v_lshrrev_b32 v162, 3, v0
    v_bfe_u32 v163, v162, 1, 1
    v_or_b32 v163, 2, v163
    v_bfe_u32 v164, v0, 1, 2
    v_xor_b32 v163, v163, v164
    v_lshlrev_b32 v163, 5, v163
    v_and_b32 v164, 1, v0
    v_lshl_add_u32 v163, v164, 4, v163
    v_lshl_add_u32 v161, v162, 10, v163
    s_mul_i32 s36, s3, 360448
    s_lshl_b32 s32, s31, 7
    s_add_u32 s36, s36, s32
    s_mul_i32 s37, s3, 16384
    s_add_u32 s37, s37, 65536
    s_add_u32 s34, s36, 0
    s_add_u32 m0, s37, 0
    s_nop 0
    buffer_load_dwordx4 v160, s[40:43], s34 offen lds
    s_add_u32 s34, s36, 8192
    s_add_u32 m0, s37, 1024
    s_nop 0
    buffer_load_dwordx4 v161, s[40:43], s34 offen lds
    s_add_u32 s34, s36, 16384
    s_add_u32 m0, s37, 2048
    s_nop 0
    buffer_load_dwordx4 v160, s[40:43], s34 offen lds
    s_add_u32 s34, s36, 24576
    s_add_u32 m0, s37, 3072
    s_nop 0
    buffer_load_dwordx4 v161, s[40:43], s34 offen lds
    s_add_u32 s34, s36, 32768
    s_add_u32 m0, s37, 4096
    s_nop 0
    buffer_load_dwordx4 v160, s[40:43], s34 offen lds
    s_add_u32 s34, s36, 40960
    s_add_u32 m0, s37, 5120
    s_nop 0
    buffer_load_dwordx4 v161, s[40:43], s34 offen lds
    s_add_u32 s34, s36, 49152
    s_add_u32 m0, s37, 6144
    s_nop 0
    buffer_load_dwordx4 v160, s[40:43], s34 offen lds
    s_add_u32 s34, s36, 57344
    s_add_u32 m0, s37, 7168
    s_nop 0
    buffer_load_dwordx4 v161, s[40:43], s34 offen lds
    s_add_u32 s34, s36, 65536
    s_add_u32 m0, s37, 8192
    s_nop 0
    buffer_load_dwordx4 v160, s[40:43], s34 offen lds
    s_add_u32 s34, s36, 73728
    s_add_u32 m0, s37, 9216
    s_nop 0
    buffer_load_dwordx4 v161, s[40:43], s34 offen lds
    s_add_u32 s34, s36, 81920
    s_add_u32 m0, s37, 10240
    s_nop 0
    buffer_load_dwordx4 v160, s[40:43], s34 offen lds
    s_add_u32 s34, s36, 90112
    s_add_u32 m0, s37, 11264
    s_nop 0
    buffer_load_dwordx4 v161, s[40:43], s34 offen lds
    s_add_u32 s34, s36, 98304
    s_add_u32 m0, s37, 12288
    s_nop 0
    buffer_load_dwordx4 v160, s[40:43], s34 offen lds
    s_add_u32 s34, s36, 106496
    s_add_u32 m0, s37, 13312
    s_nop 0
    buffer_load_dwordx4 v161, s[40:43], s34 offen lds
    s_add_u32 s34, s36, 114688
    s_add_u32 m0, s37, 14336
    s_nop 0
    buffer_load_dwordx4 v160, s[40:43], s34 offen lds
    s_add_u32 s34, s36, 122880
    s_add_u32 m0, s37, 15360
    s_nop 0
    buffer_load_dwordx4 v161, s[40:43], s34 offen lds
    s_waitcnt vmcnt(16)
    s_mov_b64 exec, 1
    ds_add_rtn_u32 v254, v252, v253 offset:20
    s_waitcnt lgkmcnt(0)
    v_readfirstlane_b32 s61, v254
    s_nop 3
    s_cmp_lg_u32 s61, 3
    s_cbranch_scc1 P_1074
    s_mul_i32 s63, s20, 128
    s_lshl_b32 s61, s21, 2
    s_add_u32 s63, s63, s61
    s_add_u32 s63, s63, 15761408
    v_mov_b32 v254, 0
    buffer_store_dword v251, v254, s[12:15], s63 offen sc1
    s_nop 3
P_1074:
    s_mov_b64 exec, -1
    s_add_u32 s34, s36, 131072
    buffer_load_dwordx4 v[168:171], v160, s[40:43], s34 offen
    s_add_u32 s34, s36, 139264
    buffer_load_dwordx4 v[172:175], v161, s[40:43], s34 offen
    s_add_u32 s34, s36, 147456
    buffer_load_dwordx4 v[176:179], v160, s[40:43], s34 offen
    s_add_u32 s34, s36, 155648
    buffer_load_dwordx4 v[180:183], v161, s[40:43], s34 offen
    s_add_u32 s34, s36, 163840
    buffer_load_dwordx4 v[184:187], v160, s[40:43], s34 offen
    s_add_u32 s34, s36, 172032
    buffer_load_dwordx4 v[188:191], v161, s[40:43], s34 offen
    s_add_u32 s34, s36, 180224
    buffer_load_dwordx4 v[192:195], v160, s[40:43], s34 offen
    s_add_u32 s34, s36, 188416
    buffer_load_dwordx4 v[196:199], v161, s[40:43], s34 offen
    s_add_u32 s34, s36, 196608
    buffer_load_dwordx4 v[200:203], v160, s[40:43], s34 offen
    s_add_u32 s34, s36, 204800
    buffer_load_dwordx4 v[204:207], v161, s[40:43], s34 offen
    s_add_u32 s34, s36, 212992
    buffer_load_dwordx4 v[208:211], v160, s[40:43], s34 offen
    s_add_u32 s34, s36, 221184
    buffer_load_dwordx4 v[212:215], v161, s[40:43], s34 offen
    s_add_u32 s34, s36, 229376
    buffer_load_dwordx4 v[216:219], v160, s[40:43], s34 offen
    s_add_u32 s34, s36, 237568
    buffer_load_dwordx4 v[220:223], v161, s[40:43], s34 offen
    s_add_u32 s34, s36, 245760
    buffer_load_dwordx4 v[224:227], v160, s[40:43], s34 offen
    s_add_u32 s34, s36, 253952
    buffer_load_dwordx4 v[228:231], v161, s[40:43], s34 offen
    s_add_u32 s34, s36, 262144
    buffer_load_dwordx4 v[232:235], v160, s[40:43], s34 offen
    s_add_u32 s34, s36, 270336
    buffer_load_dwordx4 v[236:239], v161, s[40:43], s34 offen
    s_add_u32 s34, s36, 278528
    buffer_load_dwordx4 v[240:243], v160, s[40:43], s34 offen
    s_add_u32 s34, s36, 286720
    buffer_load_dwordx4 v[244:247], v161, s[40:43], s34 offen
    v_lshrrev_b32 v1, 4, v0
    v_and_b32 v2, 15, v0
    v_lshrrev_b32 v10, 1, v1
    v_lshlrev_b32 v9, 11, v10
    v_and_b32 v10, 1, v1
    v_lshl_add_u32 v9, v10, 8, v9
    v_lshl_add_u32 v9, v2, 4, v9
    s_mul_i32 s35, s30, 180224
    s_mul_i32 s32, s3, 45056
    s_add_u32 s35, s35, s32
    s_add_u32 s35, s35, 4194304
    v_lshrrev_b32 v10, 2, v2
    v_lshl_add_u32 v11, v1, 3, v10
    v_lshlrev_b32 v11, 7, v11
    v_lshrrev_b32 v10, 1, v10
    v_and_b32 v12, 1, v1
    v_lshl_add_u32 v10, v12, 1, v10
    v_lshl_add_u32 v11, v10, 5, v11
    v_and_b32 v10, 3, v2
    v_lshl_add_u32 v11, v10, 3, v11
    v_xor_b32 v5, 0, v11
    v_add_u32 v5, s37, v5
    v_xor_b32 v6, 32, v11
    v_add_u32 v6, s37, v6
    v_xor_b32 v7, 64, v11
    v_add_u32 v7, s37, v7
    v_xor_b32 v8, 96, v11
    v_add_u32 v8, s37, v8
    v_lshlrev_b32 v13, 4, v0
    v_add_u32 v13, s37, v13
    s_nop 4
    s_cmp_lg_u32 s3, 0
    s_cbranch_scc1 B2p_1075
    s_mul_i32 s63, s30, 128
    s_add_u32 s63, s63, 15761408
    v_lshlrev_b32 v166, 2, v0
    s_mov_b64 exec, 0xff
    s_nop 3
Q_1076:
    buffer_load_dword v165, v166, s[12:15], s63 offen sc1
    s_waitcnt vmcnt(0)
    v_cmp_ne_u32 vcc, v251, v165
    s_nop 3
    s_cmp_eq_u64 vcc, 0
    s_cbranch_scc1 Qd_1077
    s_sub_u32 s60, s60, 1
    s_cbranch_scc0 Q_1076
    s_mov_b32 s60, 0
    v_mov_b32 v254, 267
    v_mov_b32 v255, 0
    buffer_store_dword v254, v255, s[56:59], 0 offen offset:44
    s_nop 3
Qd_1077:
    s_mov_b64 exec, -1
    s_mov_b64 exec, 1
    ds_add_u32 v252, v253 offset:32
    s_mov_b64 exec, -1
    s_nop 1
B2p_1075:
W_1078:
    ds_read_b32 v254, v252 offset:32
    s_waitcnt lgkmcnt(0)
    v_readfirstlane_b32 s61, v254
    s_nop 3
    s_cmp_ge_u32 s61, 1
    s_cbranch_scc1 Wd_1079
    s_sub_u32 s60, s60, 1
    s_cbranch_scc0 W_1078
    s_mov_b32 s60, 0
    v_mov_b32 v254, 268
    v_mov_b32 v255, 0
    buffer_store_dword v254, v255, s[56:59], 0 offen offset:48
    s_nop 3
Wd_1079:
    s_waitcnt vmcnt(0)
    s_add_u32 s33, s35, 0
    buffer_load_dwordx4 v[48:51], v9, s[12:15], s33 offen offset:0 sc1
    buffer_load_dwordx4 v[52:55], v9, s[12:15], s33 offen offset:512 sc1
    buffer_load_dwordx4 v[56:59], v9, s[12:15], s33 offen offset:1024 sc1
    buffer_load_dwordx4 v[60:63], v9, s[12:15], s33 offen offset:1536 sc1
    s_add_u32 s33, s35, 4096
    buffer_load_dwordx4 v[64:67], v9, s[12:15], s33 offen offset:0 sc1
    buffer_load_dwordx4 v[68:71], v9, s[12:15], s33 offen offset:512 sc1
    buffer_load_dwordx4 v[72:75], v9, s[12:15], s33 offen offset:1024 sc1
    buffer_load_dwordx4 v[76:79], v9, s[12:15], s33 offen offset:1536 sc1
    s_add_u32 s33, s35, 8192
    buffer_load_dwordx4 v[80:83], v9, s[12:15], s33 offen offset:0 sc1
    buffer_load_dwordx4 v[84:87], v9, s[12:15], s33 offen offset:512 sc1
    buffer_load_dwordx4 v[88:91], v9, s[12:15], s33 offen offset:1024 sc1
    buffer_load_dwordx4 v[92:95], v9, s[12:15], s33 offen offset:1536 sc1
    ds_read_b64_tr_b16 v[16:17], v5 offset:0
    ds_read_b64_tr_b16 v[18:19], v5 offset:512
    ds_read_b64_tr_b16 v[20:21], v6 offset:0
    ds_read_b64_tr_b16 v[22:23], v6 offset:512
    ds_read_b64_tr_b16 v[24:25], v7 offset:0
    ds_read_b64_tr_b16 v[26:27], v7 offset:512
    ds_read_b64_tr_b16 v[28:29], v8 offset:0
    ds_read_b64_tr_b16 v[30:31], v8 offset:512
    s_waitcnt vmcnt(8)
    s_waitcnt lgkmcnt(0)
    v_mfma_f32_16x16x32_bf16 v[96:99], v[16:19], v[48:51], 0
    ds_write_b128 v13, v[168:171] offset:0
    v_mfma_f32_16x16x32_bf16 v[100:103], v[16:19], v[52:55], 0
    ds_write_b128 v13, v[172:175] offset:1024
    v_mfma_f32_16x16x32_bf16 v[104:107], v[16:19], v[56:59], 0
    ds_write_b128 v13, v[176:179] offset:2048
    v_mfma_f32_16x16x32_bf16 v[108:111], v[16:19], v[60:63], 0
    v_mfma_f32_16x16x32_bf16 v[112:115], v[20:23], v[48:51], 0
    ds_write_b128 v13, v[180:183] offset:3072
    v_mfma_f32_16x16x32_bf16 v[116:119], v[20:23], v[52:55], 0
    ds_read_b64_tr_b16 v[32:33], v5 offset:4096
    v_mfma_f32_16x16x32_bf16 v[120:123], v[20:23], v[56:59], 0
    ds_read_b64_tr_b16 v[34:35], v5 offset:4608
    v_mfma_f32_16x16x32_bf16 v[124:127], v[20:23], v[60:63], 0
    v_mfma_f32_16x16x32_bf16 v[128:131], v[24:27], v[48:51], 0
    ds_read_b64_tr_b16 v[36:37], v6 offset:4096
    v_mfma_f32_16x16x32_bf16 v[132:135], v[24:27], v[52:55], 0
    ds_read_b64_tr_b16 v[38:39], v6 offset:4608
    v_mfma_f32_16x16x32_bf16 v[136:139], v[24:27], v[56:59], 0
    ds_read_b64_tr_b16 v[40:41], v7 offset:4096
    v_mfma_f32_16x16x32_bf16 v[140:143], v[24:27], v[60:63], 0
    v_mfma_f32_16x16x32_bf16 v[144:147], v[28:31], v[48:51], 0
    ds_read_b64_tr_b16 v[42:43], v7 offset:4608
    v_mfma_f32_16x16x32_bf16 v[148:151], v[28:31], v[52:55], 0
    ds_read_b64_tr_b16 v[44:45], v8 offset:4096
    v_mfma_f32_16x16x32_bf16 v[152:155], v[28:31], v[56:59], 0
    ds_read_b64_tr_b16 v[46:47], v8 offset:4608
    v_mfma_f32_16x16x32_bf16 v[156:159], v[28:31], v[60:63], 0
    s_add_u32 s33, s35, 12288
    buffer_load_dwordx4 v[48:51], v9, s[12:15], s33 offen offset:0 sc1
    buffer_load_dwordx4 v[52:55], v9, s[12:15], s33 offen offset:512 sc1
    buffer_load_dwordx4 v[56:59], v9, s[12:15], s33 offen offset:1024 sc1
    buffer_load_dwordx4 v[60:63], v9, s[12:15], s33 offen offset:1536 sc1
    s_waitcnt vmcnt(8)
    s_waitcnt lgkmcnt(0)
    v_mfma_f32_16x16x32_bf16 v[96:99], v[32:35], v[64:67], v[96:99]
    ds_write_b128 v13, v[184:187] offset:4096
    v_mfma_f32_16x16x32_bf16 v[100:103], v[32:35], v[68:71], v[100:103]
    ds_write_b128 v13, v[188:191] offset:5120
    v_mfma_f32_16x16x32_bf16 v[104:107], v[32:35], v[72:75], v[104:107]
    ds_write_b128 v13, v[192:195] offset:6144
    v_mfma_f32_16x16x32_bf16 v[108:111], v[32:35], v[76:79], v[108:111]
    v_mfma_f32_16x16x32_bf16 v[112:115], v[36:39], v[64:67], v[112:115]
    ds_write_b128 v13, v[196:199] offset:7168
    v_mfma_f32_16x16x32_bf16 v[116:119], v[36:39], v[68:71], v[116:119]
    ds_read_b64_tr_b16 v[16:17], v5 offset:8192
    v_mfma_f32_16x16x32_bf16 v[120:123], v[36:39], v[72:75], v[120:123]
    ds_read_b64_tr_b16 v[18:19], v5 offset:8704
    v_mfma_f32_16x16x32_bf16 v[124:127], v[36:39], v[76:79], v[124:127]
    v_mfma_f32_16x16x32_bf16 v[128:131], v[40:43], v[64:67], v[128:131]
    ds_read_b64_tr_b16 v[20:21], v6 offset:8192
    v_mfma_f32_16x16x32_bf16 v[132:135], v[40:43], v[68:71], v[132:135]
    ds_read_b64_tr_b16 v[22:23], v6 offset:8704
    v_mfma_f32_16x16x32_bf16 v[136:139], v[40:43], v[72:75], v[136:139]
    ds_read_b64_tr_b16 v[24:25], v7 offset:8192
    v_mfma_f32_16x16x32_bf16 v[140:143], v[40:43], v[76:79], v[140:143]
    v_mfma_f32_16x16x32_bf16 v[144:147], v[44:47], v[64:67], v[144:147]
    ds_read_b64_tr_b16 v[26:27], v7 offset:8704
    v_mfma_f32_16x16x32_bf16 v[148:151], v[44:47], v[68:71], v[148:151]
    ds_read_b64_tr_b16 v[28:29], v8 offset:8192
    v_mfma_f32_16x16x32_bf16 v[152:155], v[44:47], v[72:75], v[152:155]
    ds_read_b64_tr_b16 v[30:31], v8 offset:8704
    v_mfma_f32_16x16x32_bf16 v[156:159], v[44:47], v[76:79], v[156:159]
    s_add_u32 s33, s35, 16384
    buffer_load_dwordx4 v[64:67], v9, s[12:15], s33 offen offset:0 sc1
    buffer_load_dwordx4 v[68:71], v9, s[12:15], s33 offen offset:512 sc1
    buffer_load_dwordx4 v[72:75], v9, s[12:15], s33 offen offset:1024 sc1
    buffer_load_dwordx4 v[76:79], v9, s[12:15], s33 offen offset:1536 sc1
    s_waitcnt vmcnt(8)
    s_waitcnt lgkmcnt(0)
    v_mfma_f32_16x16x32_bf16 v[96:99], v[16:19], v[80:83], v[96:99]
    ds_write_b128 v13, v[200:203] offset:8192
    v_mfma_f32_16x16x32_bf16 v[100:103], v[16:19], v[84:87], v[100:103]
    ds_write_b128 v13, v[204:207] offset:9216
    v_mfma_f32_16x16x32_bf16 v[104:107], v[16:19], v[88:91], v[104:107]
    ds_write_b128 v13, v[208:211] offset:10240
    v_mfma_f32_16x16x32_bf16 v[108:111], v[16:19], v[92:95], v[108:111]
    v_mfma_f32_16x16x32_bf16 v[112:115], v[20:23], v[80:83], v[112:115]
    ds_write_b128 v13, v[212:215] offset:11264
    v_mfma_f32_16x16x32_bf16 v[116:119], v[20:23], v[84:87], v[116:119]
    ds_read_b64_tr_b16 v[32:33], v5 offset:12288
    v_mfma_f32_16x16x32_bf16 v[120:123], v[20:23], v[88:91], v[120:123]
    ds_read_b64_tr_b16 v[34:35], v5 offset:12800
    v_mfma_f32_16x16x32_bf16 v[124:127], v[20:23], v[92:95], v[124:127]
    v_mfma_f32_16x16x32_bf16 v[128:131], v[24:27], v[80:83], v[128:131]
    ds_read_b64_tr_b16 v[36:37], v6 offset:12288
    v_mfma_f32_16x16x32_bf16 v[132:135], v[24:27], v[84:87], v[132:135]
    ds_read_b64_tr_b16 v[38:39], v6 offset:12800
    v_mfma_f32_16x16x32_bf16 v[136:139], v[24:27], v[88:91], v[136:139]
    ds_read_b64_tr_b16 v[40:41], v7 offset:12288
    v_mfma_f32_16x16x32_bf16 v[140:143], v[24:27], v[92:95], v[140:143]
    v_mfma_f32_16x16x32_bf16 v[144:147], v[28:31], v[80:83], v[144:147]
    ds_read_b64_tr_b16 v[42:43], v7 offset:12800
    v_mfma_f32_16x16x32_bf16 v[148:151], v[28:31], v[84:87], v[148:151]
    ds_read_b64_tr_b16 v[44:45], v8 offset:12288
    v_mfma_f32_16x16x32_bf16 v[152:155], v[28:31], v[88:91], v[152:155]
    ds_read_b64_tr_b16 v[46:47], v8 offset:12800
    v_mfma_f32_16x16x32_bf16 v[156:159], v[28:31], v[92:95], v[156:159]
    s_add_u32 s33, s35, 20480
    buffer_load_dwordx4 v[80:83], v9, s[12:15], s33 offen offset:0 sc1
    buffer_load_dwordx4 v[84:87], v9, s[12:15], s33 offen offset:512 sc1
    buffer_load_dwordx4 v[88:91], v9, s[12:15], s33 offen offset:1024 sc1
    buffer_load_dwordx4 v[92:95], v9, s[12:15], s33 offen offset:1536 sc1
    s_waitcnt vmcnt(8)
    s_waitcnt lgkmcnt(0)
    v_mfma_f32_16x16x32_bf16 v[96:99], v[32:35], v[48:51], v[96:99]
    ds_write_b128 v13, v[216:219] offset:12288
    v_mfma_f32_16x16x32_bf16 v[100:103], v[32:35], v[52:55], v[100:103]
    ds_write_b128 v13, v[220:223] offset:13312
    v_mfma_f32_16x16x32_bf16 v[104:107], v[32:35], v[56:59], v[104:107]
    ds_write_b128 v13, v[224:227] offset:14336
    v_mfma_f32_16x16x32_bf16 v[108:111], v[32:35], v[60:63], v[108:111]
    v_mfma_f32_16x16x32_bf16 v[112:115], v[36:39], v[48:51], v[112:115]
    ds_write_b128 v13, v[228:231] offset:15360
    v_mfma_f32_16x16x32_bf16 v[116:119], v[36:39], v[52:55], v[116:119]
    ds_read_b64_tr_b16 v[16:17], v5 offset:0
    v_mfma_f32_16x16x32_bf16 v[120:123], v[36:39], v[56:59], v[120:123]
    ds_read_b64_tr_b16 v[18:19], v5 offset:512
    v_mfma_f32_16x16x32_bf16 v[124:127], v[36:39], v[60:63], v[124:127]
    v_mfma_f32_16x16x32_bf16 v[128:131], v[40:43], v[48:51], v[128:131]
    ds_read_b64_tr_b16 v[20:21], v6 offset:0
    v_mfma_f32_16x16x32_bf16 v[132:135], v[40:43], v[52:55], v[132:135]
    ds_read_b64_tr_b16 v[22:23], v6 offset:512
    v_mfma_f32_16x16x32_bf16 v[136:139], v[40:43], v[56:59], v[136:139]
    ds_read_b64_tr_b16 v[24:25], v7 offset:0
    v_mfma_f32_16x16x32_bf16 v[140:143], v[40:43], v[60:63], v[140:143]
    v_mfma_f32_16x16x32_bf16 v[144:147], v[44:47], v[48:51], v[144:147]
    ds_read_b64_tr_b16 v[26:27], v7 offset:512
    v_mfma_f32_16x16x32_bf16 v[148:151], v[44:47], v[52:55], v[148:151]
    ds_read_b64_tr_b16 v[28:29], v8 offset:0
    v_mfma_f32_16x16x32_bf16 v[152:155], v[44:47], v[56:59], v[152:155]
    ds_read_b64_tr_b16 v[30:31], v8 offset:512
    v_mfma_f32_16x16x32_bf16 v[156:159], v[44:47], v[60:63], v[156:159]
    s_add_u32 s33, s35, 24576
    buffer_load_dwordx4 v[48:51], v9, s[12:15], s33 offen offset:0 sc1
    buffer_load_dwordx4 v[52:55], v9, s[12:15], s33 offen offset:512 sc1
    buffer_load_dwordx4 v[56:59], v9, s[12:15], s33 offen offset:1024 sc1
    buffer_load_dwordx4 v[60:63], v9, s[12:15], s33 offen offset:1536 sc1
    s_waitcnt vmcnt(8)
    s_waitcnt lgkmcnt(0)
    v_mfma_f32_16x16x32_bf16 v[96:99], v[16:19], v[64:67], v[96:99]
    ds_write_b128 v13, v[232:235] offset:0
    v_mfma_f32_16x16x32_bf16 v[100:103], v[16:19], v[68:71], v[100:103]
    ds_write_b128 v13, v[236:239] offset:1024
    v_mfma_f32_16x16x32_bf16 v[104:107], v[16:19], v[72:75], v[104:107]
    ds_write_b128 v13, v[240:243] offset:2048
    v_mfma_f32_16x16x32_bf16 v[108:111], v[16:19], v[76:79], v[108:111]
    v_mfma_f32_16x16x32_bf16 v[112:115], v[20:23], v[64:67], v[112:115]
    ds_write_b128 v13, v[244:247] offset:3072
    v_mfma_f32_16x16x32_bf16 v[116:119], v[20:23], v[68:71], v[116:119]
    ds_read_b64_tr_b16 v[32:33], v5 offset:4096
    v_mfma_f32_16x16x32_bf16 v[120:123], v[20:23], v[72:75], v[120:123]
    ds_read_b64_tr_b16 v[34:35], v5 offset:4608
    v_mfma_f32_16x16x32_bf16 v[124:127], v[20:23], v[76:79], v[124:127]
    v_mfma_f32_16x16x32_bf16 v[128:131], v[24:27], v[64:67], v[128:131]
    ds_read_b64_tr_b16 v[36:37], v6 offset:4096
    v_mfma_f32_16x16x32_bf16 v[132:135], v[24:27], v[68:71], v[132:135]
    ds_read_b64_tr_b16 v[38:39], v6 offset:4608
    v_mfma_f32_16x16x32_bf16 v[136:139], v[24:27], v[72:75], v[136:139]
    ds_read_b64_tr_b16 v[40:41], v7 offset:4096
    v_mfma_f32_16x16x32_bf16 v[140:143], v[24:27], v[76:79], v[140:143]
    v_mfma_f32_16x16x32_bf16 v[144:147], v[28:31], v[64:67], v[144:147]
    ds_read_b64_tr_b16 v[42:43], v7 offset:4608
    v_mfma_f32_16x16x32_bf16 v[148:151], v[28:31], v[68:71], v[148:151]
    ds_read_b64_tr_b16 v[44:45], v8 offset:4096
    v_mfma_f32_16x16x32_bf16 v[152:155], v[28:31], v[72:75], v[152:155]
    ds_read_b64_tr_b16 v[46:47], v8 offset:4608
    v_mfma_f32_16x16x32_bf16 v[156:159], v[28:31], v[76:79], v[156:159]
    s_add_u32 s33, s35, 28672
    buffer_load_dwordx4 v[64:67], v9, s[12:15], s33 offen offset:0 sc1
    buffer_load_dwordx4 v[68:71], v9, s[12:15], s33 offen offset:512 sc1
    buffer_load_dwordx4 v[72:75], v9, s[12:15], s33 offen offset:1024 sc1
    buffer_load_dwordx4 v[76:79], v9, s[12:15], s33 offen offset:1536 sc1
    s_waitcnt vmcnt(8)
    s_waitcnt lgkmcnt(0)
    v_mfma_f32_16x16x32_bf16 v[96:99], v[32:35], v[80:83], v[96:99]
    s_add_u32 s34, s36, 294912
    s_add_u32 m0, s37, 4096
    s_nop 0
    buffer_load_dwordx4 v160, s[40:43], s34 offen lds
    v_mfma_f32_16x16x32_bf16 v[100:103], v[32:35], v[84:87], v[100:103]
    s_add_u32 s34, s36, 303104
    s_add_u32 m0, s37, 5120
    s_nop 0
    buffer_load_dwordx4 v161, s[40:43], s34 offen lds
    v_mfma_f32_16x16x32_bf16 v[104:107], v[32:35], v[88:91], v[104:107]
    s_add_u32 s34, s36, 311296
    s_add_u32 m0, s37, 6144
    s_nop 0
    buffer_load_dwordx4 v160, s[40:43], s34 offen lds
    v_mfma_f32_16x16x32_bf16 v[108:111], v[32:35], v[92:95], v[108:111]
    v_mfma_f32_16x16x32_bf16 v[112:115], v[36:39], v[80:83], v[112:115]
    s_add_u32 s34, s36, 319488
    s_add_u32 m0, s37, 7168
    s_nop 0
    buffer_load_dwordx4 v161, s[40:43], s34 offen lds
    v_mfma_f32_16x16x32_bf16 v[116:119], v[36:39], v[84:87], v[116:119]
    ds_read_b64_tr_b16 v[16:17], v5 offset:8192
    v_mfma_f32_16x16x32_bf16 v[120:123], v[36:39], v[88:91], v[120:123]
    ds_read_b64_tr_b16 v[18:19], v5 offset:8704
    v_mfma_f32_16x16x32_bf16 v[124:127], v[36:39], v[92:95], v[124:127]
    v_mfma_f32_16x16x32_bf16 v[128:131], v[40:43], v[80:83], v[128:131]
    ds_read_b64_tr_b16 v[20:21], v6 offset:8192
    v_mfma_f32_16x16x32_bf16 v[132:135], v[40:43], v[84:87], v[132:135]
    ds_read_b64_tr_b16 v[22:23], v6 offset:8704
    v_mfma_f32_16x16x32_bf16 v[136:139], v[40:43], v[88:91], v[136:139]
    ds_read_b64_tr_b16 v[24:25], v7 offset:8192
    v_mfma_f32_16x16x32_bf16 v[140:143], v[40:43], v[92:95], v[140:143]
    v_mfma_f32_16x16x32_bf16 v[144:147], v[44:47], v[80:83], v[144:147]
    ds_read_b64_tr_b16 v[26:27], v7 offset:8704
    v_mfma_f32_16x16x32_bf16 v[148:151], v[44:47], v[84:87], v[148:151]
    ds_read_b64_tr_b16 v[28:29], v8 offset:8192
    v_mfma_f32_16x16x32_bf16 v[152:155], v[44:47], v[88:91], v[152:155]
    ds_read_b64_tr_b16 v[30:31], v8 offset:8704
    v_mfma_f32_16x16x32_bf16 v[156:159], v[44:47], v[92:95], v[156:159]
    s_add_u32 s33, s35, 32768
    buffer_load_dwordx4 v[80:83], v9, s[12:15], s33 offen offset:0 sc1
    buffer_load_dwordx4 v[84:87], v9, s[12:15], s33 offen offset:512 sc1
    buffer_load_dwordx4 v[88:91], v9, s[12:15], s33 offen offset:1024 sc1
    buffer_load_dwordx4 v[92:95], v9, s[12:15], s33 offen offset:1536 sc1
    s_waitcnt vmcnt(12)
    s_waitcnt lgkmcnt(0)
    v_mfma_f32_16x16x32_bf16 v[96:99], v[16:19], v[48:51], v[96:99]
    s_add_u32 s34, s36, 327680
    s_add_u32 m0, s37, 8192
    s_nop 0
    buffer_load_dwordx4 v160, s[40:43], s34 offen lds
    v_mfma_f32_16x16x32_bf16 v[100:103], v[16:19], v[52:55], v[100:103]
    s_add_u32 s34, s36, 335872
    s_add_u32 m0, s37, 9216
    s_nop 0
    buffer_load_dwordx4 v161, s[40:43], s34 offen lds
    v_mfma_f32_16x16x32_bf16 v[104:107], v[16:19], v[56:59], v[104:107]
    s_add_u32 s34, s36, 344064
    s_add_u32 m0, s37, 10240
    s_nop 0
    buffer_load_dwordx4 v160, s[40:43], s34 offen lds
    v_mfma_f32_16x16x32_bf16 v[108:111], v[16:19], v[60:63], v[108:111]
    v_mfma_f32_16x16x32_bf16 v[112:115], v[20:23], v[48:51], v[112:115]
    s_add_u32 s34, s36, 352256
    s_add_u32 m0, s37, 11264
    s_nop 0
    buffer_load_dwordx4 v161, s[40:43], s34 offen lds
    v_mfma_f32_16x16x32_bf16 v[116:119], v[20:23], v[52:55], v[116:119]
    ds_read_b64_tr_b16 v[32:33], v5 offset:12288
    v_mfma_f32_16x16x32_bf16 v[120:123], v[20:23], v[56:59], v[120:123]
    ds_read_b64_tr_b16 v[34:35], v5 offset:12800
    v_mfma_f32_16x16x32_bf16 v[124:127], v[20:23], v[60:63], v[124:127]
    v_mfma_f32_16x16x32_bf16 v[128:131], v[24:27], v[48:51], v[128:131]
    ds_read_b64_tr_b16 v[36:37], v6 offset:12288
    v_mfma_f32_16x16x32_bf16 v[132:135], v[24:27], v[52:55], v[132:135]
    ds_read_b64_tr_b16 v[38:39], v6 offset:12800
    v_mfma_f32_16x16x32_bf16 v[136:139], v[24:27], v[56:59], v[136:139]
    ds_read_b64_tr_b16 v[40:41], v7 offset:12288
    v_mfma_f32_16x16x32_bf16 v[140:143], v[24:27], v[60:63], v[140:143]
    v_mfma_f32_16x16x32_bf16 v[144:147], v[28:31], v[48:51], v[144:147]
    ds_read_b64_tr_b16 v[42:43], v7 offset:12800
    v_mfma_f32_16x16x32_bf16 v[148:151], v[28:31], v[52:55], v[148:151]
    ds_read_b64_tr_b16 v[44:45], v8 offset:12288
    v_mfma_f32_16x16x32_bf16 v[152:155], v[28:31], v[56:59], v[152:155]
    ds_read_b64_tr_b16 v[46:47], v8 offset:12800
    v_mfma_f32_16x16x32_bf16 v[156:159], v[28:31], v[60:63], v[156:159]
    s_add_u32 s33, s35, 36864
    buffer_load_dwordx4 v[48:51], v9, s[12:15], s33 offen offset:0 sc1
    buffer_load_dwordx4 v[52:55], v9, s[12:15], s33 offen offset:512 sc1
    buffer_load_dwordx4 v[56:59], v9, s[12:15], s33 offen offset:1024 sc1
    buffer_load_dwordx4 v[60:63], v9, s[12:15], s33 offen offset:1536 sc1
    s_waitcnt vmcnt(16)
    s_waitcnt lgkmcnt(0)
    v_mfma_f32_16x16x32_bf16 v[96:99], v[32:35], v[64:67], v[96:99]
    ds_read_b64_tr_b16 v[16:17], v5 offset:0
    v_mfma_f32_16x16x32_bf16 v[100:103], v[32:35], v[68:71], v[100:103]
    v_mfma_f32_16x16x32_bf16 v[104:107], v[32:35], v[72:75], v[104:107]
    ds_read_b64_tr_b16 v[18:19], v5 offset:512
    v_mfma_f32_16x16x32_bf16 v[108:111], v[32:35], v[76:79], v[108:111]
    v_mfma_f32_16x16x32_bf16 v[112:115], v[36:39], v[64:67], v[112:115]
    ds_read_b64_tr_b16 v[20:21], v6 offset:0
    v_mfma_f32_16x16x32_bf16 v[116:119], v[36:39], v[68:71], v[116:119]
    v_mfma_f32_16x16x32_bf16 v[120:123], v[36:39], v[72:75], v[120:123]
    ds_read_b64_tr_b16 v[22:23], v6 offset:512
    v_mfma_f32_16x16x32_bf16 v[124:127], v[36:39], v[76:79], v[124:127]
    v_mfma_f32_16x16x32_bf16 v[128:131], v[40:43], v[64:67], v[128:131]
    ds_read_b64_tr_b16 v[24:25], v7 offset:0
    v_mfma_f32_16x16x32_bf16 v[132:135], v[40:43], v[68:71], v[132:135]
    v_mfma_f32_16x16x32_bf16 v[136:139], v[40:43], v[72:75], v[136:139]
    ds_read_b64_tr_b16 v[26:27], v7 offset:512
    v_mfma_f32_16x16x32_bf16 v[140:143], v[40:43], v[76:79], v[140:143]
    v_mfma_f32_16x16x32_bf16 v[144:147], v[44:47], v[64:67], v[144:147]
    ds_read_b64_tr_b16 v[28:29], v8 offset:0
    v_mfma_f32_16x16x32_bf16 v[148:151], v[44:47], v[68:71], v[148:151]
    v_mfma_f32_16x16x32_bf16 v[152:155], v[44:47], v[72:75], v[152:155]
    ds_read_b64_tr_b16 v[30:31], v8 offset:512
    v_mfma_f32_16x16x32_bf16 v[156:159], v[44:47], v[76:79], v[156:159]
    s_add_u32 s33, s35, 40960
    buffer_load_dwordx4 v[64:67], v9, s[12:15], s33 offen offset:0 sc1
    buffer_load_dwordx4 v[68:71], v9, s[12:15], s33 offen offset:512 sc1
    buffer_load_dwordx4 v[72:75], v9, s[12:15], s33 offen offset:1024 sc1
    buffer_load_dwordx4 v[76:79], v9, s[12:15], s33 offen offset:1536 sc1
    s_waitcnt vmcnt(12)
    s_waitcnt lgkmcnt(0)
    v_mfma_f32_16x16x32_bf16 v[96:99], v[16:19], v[80:83], v[96:99]
    s_waitcnt vmcnt(16)
    v_mfma_f32_16x16x32_bf16 v[100:103], v[16:19], v[84:87], v[100:103]
    ds_read_b64_tr_b16 v[32:33], v5 offset:4096
    v_mfma_f32_16x16x32_bf16 v[104:107], v[16:19], v[88:91], v[104:107]
    v_mfma_f32_16x16x32_bf16 v[108:111], v[16:19], v[92:95], v[108:111]
    ds_read_b64_tr_b16 v[34:35], v5 offset:4608
    v_mfma_f32_16x16x32_bf16 v[112:115], v[20:23], v[80:83], v[112:115]
    v_mfma_f32_16x16x32_bf16 v[116:119], v[20:23], v[84:87], v[116:119]
    ds_read_b64_tr_b16 v[36:37], v6 offset:4096
    v_mfma_f32_16x16x32_bf16 v[120:123], v[20:23], v[88:91], v[120:123]
    v_mfma_f32_16x16x32_bf16 v[124:127], v[20:23], v[92:95], v[124:127]
    ds_read_b64_tr_b16 v[38:39], v6 offset:4608
    v_mfma_f32_16x16x32_bf16 v[128:131], v[24:27], v[80:83], v[128:131]
    ds_read_b64_tr_b16 v[40:41], v7 offset:4096
    v_mfma_f32_16x16x32_bf16 v[132:135], v[24:27], v[84:87], v[132:135]
    v_mfma_f32_16x16x32_bf16 v[136:139], v[24:27], v[88:91], v[136:139]
    ds_read_b64_tr_b16 v[42:43], v7 offset:4608
    v_mfma_f32_16x16x32_bf16 v[140:143], v[24:27], v[92:95], v[140:143]
    v_mfma_f32_16x16x32_bf16 v[144:147], v[28:31], v[80:83], v[144:147]
    ds_read_b64_tr_b16 v[44:45], v8 offset:4096
    v_mfma_f32_16x16x32_bf16 v[148:151], v[28:31], v[84:87], v[148:151]
    v_mfma_f32_16x16x32_bf16 v[152:155], v[28:31], v[88:91], v[152:155]
    ds_read_b64_tr_b16 v[46:47], v8 offset:4608
    v_mfma_f32_16x16x32_bf16 v[156:159], v[28:31], v[92:95], v[156:159]
    s_waitcnt vmcnt(4)
    s_waitcnt lgkmcnt(0)
    v_mfma_f32_16x16x32_bf16 v[96:99], v[32:35], v[48:51], v[96:99]
    s_waitcnt vmcnt(8)
    v_mfma_f32_16x16x32_bf16 v[100:103], v[32:35], v[52:55], v[100:103]
    ds_read_b64_tr_b16 v[16:17], v5 offset:8192
    v_mfma_f32_16x16x32_bf16 v[104:107], v[32:35], v[56:59], v[104:107]
    v_mfma_f32_16x16x32_bf16 v[108:111], v[32:35], v[60:63], v[108:111]
    ds_read_b64_tr_b16 v[18:19], v5 offset:8704
    v_mfma_f32_16x16x32_bf16 v[112:115], v[36:39], v[48:51], v[112:115]
    v_mfma_f32_16x16x32_bf16 v[116:119], v[36:39], v[52:55], v[116:119]
    ds_read_b64_tr_b16 v[20:21], v6 offset:8192
    v_mfma_f32_16x16x32_bf16 v[120:123], v[36:39], v[56:59], v[120:123]
    v_mfma_f32_16x16x32_bf16 v[124:127], v[36:39], v[60:63], v[124:127]
    ds_read_b64_tr_b16 v[22:23], v6 offset:8704
    v_mfma_f32_16x16x32_bf16 v[128:131], v[40:43], v[48:51], v[128:131]
    ds_read_b64_tr_b16 v[24:25], v7 offset:8192
    v_mfma_f32_16x16x32_bf16 v[132:135], v[40:43], v[52:55], v[132:135]
    v_mfma_f32_16x16x32_bf16 v[136:139], v[40:43], v[56:59], v[136:139]
    ds_read_b64_tr_b16 v[26:27], v7 offset:8704
    v_mfma_f32_16x16x32_bf16 v[140:143], v[40:43], v[60:63], v[140:143]
    v_mfma_f32_16x16x32_bf16 v[144:147], v[44:47], v[48:51], v[144:147]
    ds_read_b64_tr_b16 v[28:29], v8 offset:8192
    v_mfma_f32_16x16x32_bf16 v[148:151], v[44:47], v[52:55], v[148:151]
    v_mfma_f32_16x16x32_bf16 v[152:155], v[44:47], v[56:59], v[152:155]
    ds_read_b64_tr_b16 v[30:31], v8 offset:8704
    v_mfma_f32_16x16x32_bf16 v[156:159], v[44:47], v[60:63], v[156:159]
    s_waitcnt vmcnt(0)
    s_waitcnt lgkmcnt(0)
    s_nop 5
    s_cmp_lg_u32 s3, 3
    s_cbranch_scc1 B2z_1080
    v_mov_b32 v64, 0
    v_mov_b32 v65, 0
    v_mov_b32 v66, 0
    v_mov_b32 v67, 0
    v_mov_b32 v68, 0
    v_mov_b32 v69, 0
    v_mov_b32 v70, 0
    v_mov_b32 v71, 0
    v_mov_b32 v72, 0
    v_mov_b32 v73, 0
    v_mov_b32 v74, 0
    v_mov_b32 v75, 0
    v_mov_b32 v76, 0
    v_mov_b32 v77, 0
    v_mov_b32 v78, 0
    v_mov_b32 v79, 0
    s_nop 4
B2z_1080:
    v_mfma_f32_16x16x32_bf16 v[96:99], v[16:19], v[64:67], v[96:99]
    v_mfma_f32_16x16x32_bf16 v[112:115], v[20:23], v[64:67], v[112:115]
    v_mfma_f32_16x16x32_bf16 v[128:131], v[24:27], v[64:67], v[128:131]
    v_mfma_f32_16x16x32_bf16 v[144:147], v[28:31], v[64:67], v[144:147]
    v_mfma_f32_16x16x32_bf16 v[100:103], v[16:19], v[68:71], v[100:103]
    v_mfma_f32_16x16x32_bf16 v[116:119], v[20:23], v[68:71], v[116:119]
    v_mfma_f32_16x16x32_bf16 v[132:135], v[24:27], v[68:71], v[132:135]
    v_mfma_f32_16x16x32_bf16 v[148:151], v[28:31], v[68:71], v[148:151]
    v_mfma_f32_16x16x32_bf16 v[104:107], v[16:19], v[72:75], v[104:107]
    ds_write_b128 v13, v[96:99] offset:0
    v_mfma_f32_16x16x32_bf16 v[120:123], v[20:23], v[72:75], v[120:123]
    ds_write_b128 v13, v[112:115] offset:4096
    v_mfma_f32_16x16x32_bf16 v[136:139], v[24:27], v[72:75], v[136:139]
    ds_write_b128 v13, v[128:131] offset:8192
    v_mfma_f32_16x16x32_bf16 v[152:155], v[28:31], v[72:75], v[152:155]
    ds_write_b128 v13, v[144:147] offset:12288
    v_mfma_f32_16x16x32_bf16 v[108:111], v[16:19], v[76:79], v[108:111]
    ds_write_b128 v13, v[100:103] offset:1024
    v_mfma_f32_16x16x32_bf16 v[124:127], v[20:23], v[76:79], v[124:127]
    ds_write_b128 v13, v[116:119] offset:5120
    v_mfma_f32_16x16x32_bf16 v[140:143], v[24:27], v[76:79], v[140:143]
    ds_write_b128 v13, v[132:135] offset:9216
    v_mfma_f32_16x16x32_bf16 v[156:159], v[28:31], v[76:79], v[156:159]
    ds_write_b128 v13, v[148:151] offset:13312
    s_mov_b64 exec, 1
    ds_add_u32 v252, v253 offset:36
    s_mov_b64 exec, -1
    ds_write_b128 v13, v[104:107] offset:2048
    ds_write_b128 v13, v[120:123] offset:6144
    ds_write_b128 v13, v[136:139] offset:10240
    ds_write_b128 v13, v[152:155] offset:14336
    ds_write_b128 v13, v[108:111] offset:3072
    ds_write_b128 v13, v[124:127] offset:7168
    ds_write_b128 v13, v[140:143] offset:11264
    ds_write_b128 v13, v[156:159] offset:15360
    s_mov_b64 exec, 1
    ds_add_u32 v252, v253 offset:96
    s_mov_b64 exec, -1
    s_waitcnt lgkmcnt(0)
    s_nop 1
    s_branch L_fin
    s_nop 1
XS_1057:
    s_nop 4
W_1081:
    ds_read_b32 v254, v252 offset:68
    s_waitcnt lgkmcnt(0)
    v_readfirstlane_b32 s61, v254
    s_nop 3
    s_cmp_ge_u32 s61, 4
    s_cbranch_scc1 Wd_1082
    s_sub_u32 s60, s60, 1
    s_cbranch_scc0 W_1081
    s_mov_b32 s60, 0
    v_mov_b32 v254, 269
    v_mov_b32 v255, 0
    buffer_store_dword v254, v255, s[56:59], 0 offen offset:52
    s_nop 3
Wd_1082:
    s_branch XB_1058
    s_nop 1
XS_1059:
    s_nop 4
W_1083:
    ds_read_b32 v254, v252 offset:72
    s_waitcnt lgkmcnt(0)
    v_readfirstlane_b32 s61, v254
    s_nop 3
    s_cmp_ge_u32 s61, 4
    s_cbranch_scc1 Wd_1084
    s_sub_u32 s60, s60, 1
    s_cbranch_scc0 W_1083
    s_mov_b32 s60, 0
    v_mov_b32 v254, 269
    v_mov_b32 v255, 0
    buffer_store_dword v254, v255, s[56:59], 0 offen offset:52
    s_nop 3
Wd_1084:
    s_branch XB_1060
    s_nop 1
XS_1061:
    s_nop 4
W_1085:
    ds_read_b32 v254, v252 offset:76
    s_waitcnt lgkmcnt(0)
    v_readfirstlane_b32 s61, v254
    s_nop 3
    s_cmp_ge_u32 s61, 4
    s_cbranch_scc1 Wd_1086
    s_sub_u32 s60, s60, 1
    s_cbranch_scc0 W_1085
    s_mov_b32 s60, 0
    v_mov_b32 v254, 269
    v_mov_b32 v255, 0
    buffer_store_dword v254, v255, s[56:59], 0 offen offset:52
    s_nop 3
Wd_1086:
    s_branch XB_1062
    s_nop 1
XS_1063:
    s_nop 4
W_1087:
    ds_read_b32 v254, v252 offset:80
    s_waitcnt lgkmcnt(0)
    v_readfirstlane_b32 s61, v254
    s_nop 3
    s_cmp_ge_u32 s61, 4
    s_cbranch_scc1 Wd_1088
    s_sub_u32 s60, s60, 1
    s_cbranch_scc0 W_1087
    s_mov_b32 s60, 0
    v_mov_b32 v254, 269
    v_mov_b32 v255, 0
    buffer_store_dword v254, v255, s[56:59], 0 offen offset:52
    s_nop 3
Wd_1088:
    s_branch XB_1064
    s_nop 1
XS_1065:
    s_nop 4
W_1089:
    ds_read_b32 v254, v252 offset:84
    s_waitcnt lgkmcnt(0)
    v_readfirstlane_b32 s61, v254
    s_nop 3
    s_cmp_ge_u32 s61, 4
    s_cbranch_scc1 Wd_1090
    s_sub_u32 s60, s60, 1
    s_cbranch_scc0 W_1089
    s_mov_b32 s60, 0
    v_mov_b32 v254, 269
    v_mov_b32 v255, 0
    buffer_store_dword v254, v255, s[56:59], 0 offen offset:52
    s_nop 3
Wd_1090:
    s_branch XB_1066
    s_nop 1
XS_1067:
    s_nop 4
W_1091:
    ds_read_b32 v254, v252 offset:88
    s_waitcnt lgkmcnt(0)
    v_readfirstlane_b32 s61, v254
    s_nop 3
    s_cmp_ge_u32 s61, 4
    s_cbranch_scc1 Wd_1092
    s_sub_u32 s60, s60, 1
    s_cbranch_scc0 W_1091
    s_mov_b32 s60, 0
    v_mov_b32 v254, 269
    v_mov_b32 v255, 0
    buffer_store_dword v254, v255, s[56:59], 0 offen offset:52
    s_nop 3
Wd_1092:
    s_branch XB_1068
    s_nop 1
XS_1069:
    s_nop 4
W_1093:
    ds_read_b32 v254, v252 offset:92
    s_waitcnt lgkmcnt(0)
    v_readfirstlane_b32 s61, v254
    s_nop 3
    s_cmp_ge_u32 s61, 4
    s_cbranch_scc1 Wd_1094
    s_sub_u32 s60, s60, 1
    s_cbranch_scc0 W_1093
    s_mov_b32 s60, 0
    v_mov_b32 v254, 269
    v_mov_b32 v255, 0
    buffer_store_dword v254, v255, s[56:59], 0 offen offset:52
    s_nop 3
Wd_1094:
    s_branch XB_1070
L_fin:
    s_nop 1
L_end:
    s_endpgm
.section .rodata,"a"
.p2align 6
.amdhsa_kernel gated_mix__spectral_gfnet__dense_activation_gelu__prompt_kernel
  .amdhsa_next_free_vgpr 256
  .amdhsa_next_free_sgpr 100
  .amdhsa_accum_offset 256
  .amdhsa_group_segment_fixed_size 0
  .amdhsa_kernarg_size 96
  .amdhsa_user_sgpr_count 2
  .amdhsa_user_sgpr_kernarg_segment_ptr 1
  .amdhsa_system_sgpr_workgroup_id_x 1
.end_amdhsa_kernel
```
